```python
import torch

def _softmax(x, axis=-1):
    return torch.softmax(x, dim=axis)
def _gelu(x):
    return torch.nn.functional.gelu(x, approximate="tanh")
def _silu(x):
    return torch.nn.functional.silu(x)
def _sigmoid(x):
    return torch.sigmoid(x)
def _layernorm(x, axis=-1, eps=1e-5):
    m = x.mean(dim=axis, keepdim=True)
    v = x.var(dim=axis, keepdim=True, unbiased=False)
    return (x - m) / torch.sqrt(v + eps)
def _scatter_add(tgt, idx, src, axis=0):
    return tgt.clone().index_add_(axis, idx, src)
def _segment_sum(src, seg, n):
    out = torch.zeros((n,) + src.shape[1:], dtype=src.dtype)
    return out.index_add_(0, seg, src)
def _pad(x, pw):
    flat = tuple(v for pair in reversed(pw) for v in pair)
    return torch.nn.functional.pad(x, flat)

kernel_name = 'standalone__edge_featured_mpnn_mpnn__graph'

def setup_inputs():

    _w = (lambda a: (lambda t: t.to(torch.bfloat16) if t.is_floating_point() else t)(torch.as_tensor(a)))
    N, deg, D, De = 50000, 16, 64, max(16, 1)
    E = N * deg
    H = 2 * D
    return {
        "x": _w((lambda *s: torch.randn(*s, dtype=torch.bfloat16) * 0.05)(N, D)),
        "e_attr": _w((lambda *s: torch.randn(*s, dtype=torch.bfloat16) * 0.8)(E, De)),
        "src": _w((lambda lo, hi, *s: torch.randint(lo, hi, s))(0, N, E).to(torch.int64)),
        "dst": _w((lambda lo, hi, *s: torch.randint(lo, hi, s))(0, N, E).to(torch.int64)),
        "w1": _w((lambda *s: torch.randn(*s, dtype=torch.bfloat16) * 0.8)(2 * D + De, H) * (1.0 / (2 * D + De) ** 0.5)),
        "b1": _w((lambda *s: torch.randn(*s, dtype=torch.bfloat16) * 0.8)(H) * 0.01),
        "w2": _w((lambda *s: torch.randn(*s, dtype=torch.bfloat16) * 0.05)(H, D) * (1.0 / H ** 0.5)),
        "b2": _w((lambda *s: torch.randn(*s, dtype=torch.bfloat16) * 0.05)(D) * 0.01),
    }

def reference(x, e_attr, src, dst, w1, b1, w2, b2):
    N, D = x.shape
    h_src = x[src]
    h_dst = x[dst]
    m_in = torch.concatenate([h_src, h_dst, e_attr], axis=-1)
    h = _silu(m_in @ w1 + b1)
    msg = h @ w2 + b2
    return _segment_sum(msg, dst, N)
```

```asm
; @launch grid=(256,1,1) block=(256,1,1) lds=163840
.amdgcn_target "amdgcn-amd-amdhsa--gfx950"
.text
.globl standalone__edge_featured_mpnn_mpnn__graph_kernel
.p2align 8
.type standalone__edge_featured_mpnn_mpnn__graph_kernel,@function
standalone__edge_featured_mpnn_mpnn__graph_kernel:
    s_load_dwordx4 s[40:43], s[0:1], 16
    s_load_dwordx2 s[24:25], s[0:1], 80
    s_load_dwordx8 s[44:51], s[0:1], 32
    s_load_dwordx4 s[4:7], s[0:1], 0
    s_load_dwordx2 s[16:17], s[0:1], 64
    s_load_dwordx2 s[68:69], s[0:1], 72
    s_cmp_ge_u32 s2, 256
    s_cbranch_scc1 k2_done
    v_lshrrev_b32 v1, 6, v0
    v_and_b32 v3, 63, v0
    v_lshlrev_b32 v5, 4, v0
    v_readfirstlane_b32 s28, v1
    s_getpc_b64 s[52:53]
k2_pc:
    s_bfe_u32 s56, s2, 0x30003
    s_mulk_i32 s56, 5120
    v_mad_u32_u24 v2, v1, 10, v3
    v_lshl_add_u32 v2, v2, 7, s56
    v_min_u32 v2, k2_slow_w-k2_pc, v2
    v_mov_b32 v9, s53
    v_add_co_u32 v8, vcc, s52, v2
    s_mov_b64 exec, 0x3ff
    s_nop 0
    v_addc_co_u32 v9, vcc, 0, v9, vcc
    global_load_dword v2, v[8:9], off
    s_mov_b64 exec, -1
    s_mul_i32 s57, s2, 12500
    s_andn2_b32 s56, s57, 127
    s_add_u32 s57, s57, 12500
    s_sub_u32 s57, s57, s56
    s_add_u32 s56, s56, 4096
    v_add_u32 v4, s56, v5
    v_add_u32 v6, 4096, v4
    s_add_u32 s56, s56, 8192
    v_lshl_add_u32 v1, v3, 2, s56
    s_cmp_ge_u32 s57, 12544
    s_cselect_b32 s33, -1, 0
    s_cmp_lg_u32 s28, 3
    s_waitcnt lgkmcnt(0)
    s_cbranch_scc1 k2_notail0
    s_mov_b32 exec_hi, s33
    global_load_dword v28, v1, s[42:43] nt
    global_load_dword v44, v1, s[40:41] nt
    s_mov_b32 exec_hi, -1
k2_notail0:
    global_load_dwordx4 v[16:19], v4, s[42:43] offset:-4096 nt
    global_load_dwordx4 v[20:23], v4, s[42:43] offset:0 nt
    global_load_dwordx4 v[24:27], v6, s[42:43] offset:0 nt
    global_load_dwordx4 v[32:35], v4, s[40:41] offset:-4096 nt
    global_load_dwordx4 v[36:39], v4, s[40:41] offset:0 nt
    global_load_dwordx4 v[40:43], v6, s[40:41] offset:0 nt
    v_mov_b64 v[8:9], -1
    v_mov_b64 v[10:11], -1
    v_mov_b64 v[144:145], 0
    v_mov_b64 v[146:147], 0
    v_add_u32 v6, 160256, v5
    ds_write_b128 v6, v[144:147]
    v_lshlrev_b32 v7, 2, v0
    v_add_u32 v7, 157696, v7
    v_mov_b32 v12, 65536
    ds_write_b32 v7, v12
    v_add_u32 v4, 65536, v5
    v_add_u32 v14, 102400, v5
    ds_write_b128 v4, v[8:11] offset:0
    ds_write_b128 v4, v[8:11] offset:4096
    ds_write_b128 v4, v[8:11] offset:8192
    s_bfe_u32 s61, s2, 0x30003
    s_lshl_b32 s61, s61, 2
    s_add_u32 s61, s61, s28
    s_mul_i32 s60, s61, 1152
    s_lshl_b32 s61, s61, 9
    v_lshl_add_u32 v232, v3, 7, s60
    v_lshl_add_u32 v233, v3, 7, s61
    s_mov_b64 exec, 0x1ff
    global_load_dword v232, v232, s[44:45]
    s_mov_b64 exec, 15
    global_load_dword v233, v233, s[48:49]
    s_mov_b64 exec, -1
    ds_write_b128 v4, v[8:11] offset:12288
    s_and_b32 s59, s2, 7
    s_lshl_b32 s29, s59, 5
    s_lshr_b32 s32, s2, 3
    s_add_u32 s29, s29, s32
    s_lshl_b32 s32, 1, s32
    s_mul_i32 s30, s29, 3125
    s_add_u32 s31, s30, 3140
    s_add_u32 s30, s30, 15
    s_lshr_b32 s30, s30, 4
    s_lshr_b32 s31, s31, 4
    s_sub_u32 s31, s31, s30
    ds_write_b128 v4, v[8:11] offset:16384
    s_mov_b32 s26, 98304
    s_mov_b32 s27, 0x00020000
    s_lshl_b32 s60, s2, 6
    s_add_u32 s20, s24, 16777216
    s_addc_u32 s21, s25, 0
    s_mov_b32 s22, 12599296
    s_mov_b32 s23, 0x00020000
    s_mov_b32 s18, 6400000
    s_mov_b32 s19, 0x00020000
    s_mov_b32 s3, 21990233
    s_movk_i32 s37, 3125
    ds_write_b128 v4, v[8:11] offset:20480
    s_movk_i32 s38, 288
    s_mov_b32 s39, 85899
    v_mov_b32 v13, 8
    s_mov_b32 s40, 157696
    v_lshlrev_b32 v80, 18, v0
    v_lshlrev_b32 v104, 16, v3
    v_add_u32 v104, 201326592, v104
    v_add_u32 v82, 65536, v80
    v_add_u32 v84, 131072, v80
    v_add_u32 v86, 196608, v80
    v_add_u32 v88, 67108864, v80
    global_load_dwordx2 v[234:235], v144, s[24:25] sc1
    ds_write_b128 v4, v[8:11] offset:24576
    v_add_u32 v90, 67174400, v80
    v_add_u32 v92, 67239936, v80
    v_add_u32 v94, 67305472, v80
    v_add_u32 v96, 134217728, v80
    v_add_u32 v98, 134283264, v80
    v_add_u32 v100, 134348800, v80
    v_add_u32 v102, 134414336, v80
    s_mul_i32 s36, s28, 10496
    s_lshl_b32 s41, s28, 10
    s_add_u32 s41, s41, 98304
    v_accvgpr_write_b32 a239, 1
    ds_write_b128 v4, v[8:11] offset:28672
    v_bfe_u32 v224, v0, 4, 1
    v_and_b32 v225, 0xf0, v5
    v_lshl_add_u32 v229, v224, 3, v225
    v_bfe_u32 v224, v0, 2, 1
    v_bfe_u32 v225, v0, 3, 2
    v_and_b32 v230, 3, v0
    v_lshl_add_u32 v230, v225, 2, v230
    v_lshl_add_u32 v230, v224, 5, v230
    v_lshlrev_b32 v230, 1, v230
    v_add_u32 v224, 4096, v5
    v_add_u32 v225, 12288, v5
    ds_write_b128 v4, v[8:11] offset:32768
    v_add_u32 v226, 20480, v5
    v_add_u32 v227, 28672, v5
    v_add_u32 v228, 36864, v5
    v_and_b32 v46, 0x3f0, v5
    s_lshl_b32 s61, s28, 6
    s_and_b32 s61, s61, 64
    v_and_b32 v244, 0x30, v3
    v_xor_b32 v244, v46, v244
    v_xor_b32 v244, s61, v244
    v_xor_b32 v245, 64, v244
    v_cmp_gt_u32 vcc, 196, v0
    ds_write_b128 v14, v[8:11] offset:0
    s_mov_b64 s[54:55], vcc
    s_sub_u32 s8, s4, 3168
    s_subb_u32 s9, s5, 0
    s_or_b32 s9, s9, 8388608
    s_mov_b32 s10, 50000
    s_mov_b32 s11, 0x00020000
    s_mov_b32 s12, s6
    s_or_b32 s13, s7, 2097152
    s_mov_b32 s14, 800000
    s_mov_b32 s15, 0x00020000
    s_add_u32 s6, s30, s31
    ds_write_b128 v14, v[8:11] offset:4096
    s_lshl_b32 s6, s6, 7
    s_mov_b32 s7, 0x00020000
    s_lshl_b32 s56, s30, 7
    s_mul_i32 s57, s28, 7168
    s_add_u32 s64, s56, s57
    s_add_u32 m0, s57, 69632
    s_add_u32 s65, s36, 5248
    s_add_u32 s66, s36, 4224
    s_add_u32 s67, s36, 9472
    s_mov_b32 s34, 2112
    s_mov_b32 s35, 1056
    ds_write_b128 v14, v[8:11] offset:8192
    v_and_b32 v250, 32, v3
    v_lshlrev_b32 v250, 3, v250
    v_add_u32 v250, 158720, v250
    v_bfe_u32 v31, v3, 2, 2
    v_lshrrev_b32 v45, 5, v3
    v_bfe_u32 v29, v3, 4, 1
    v_lshl_add_u32 v248, v45, 3, v31
    v_mul_u32_u24 v248, 320, v248
    v_lshl_add_u32 v248, v29, 5, v248
    v_and_b32 v30, 3, v3
    v_lshl_add_u32 v248, v30, 3, v248
    ds_write_b128 v14, v[8:11] offset:12288
    v_lshl_add_u32 v31, v45, 2, v31
    v_lshlrev_b32 v31, 7, v31
    v_lshl_add_u32 v31, v29, 4, v31
    v_and_b32 v45, 1, v3
    v_lshl_add_u32 v31, v45, 6, v31
    v_and_b32 v45, 2, v3
    v_lshl_add_u32 v249, v45, 2, v31
    v_accvgpr_write_b32 a209, 0
    v_accvgpr_write_b32 a210, 0
    v_accvgpr_write_b32 a211, 0
    v_accvgpr_write_b32 a213, 0
    ds_write_b128 v14, v[8:11] offset:16384
    v_accvgpr_write_b32 a214, 0
    v_accvgpr_write_b32 a215, 0
    v_lshrrev_b32 v31, 4, v3
    v_xor_b32 v45, v3, v31
    v_and_b32 v45, 1, v45
    v_lshlrev_b32 v254, 4, v45
    v_and_or_b32 v45, v3, 6, v45
    v_lshlrev_b32 v255, 4, v45
    v_bfe_u32 v45, v3, 3, 1
    v_lshl_add_u32 v45, v45, 4, v31
    v_lshlrev_b32 v242, 3, v45
    ds_write_b128 v14, v[8:11] offset:20480
    v_bfe_u32 v45, v3, 1, 1
    v_lshrrev_b32 v31, 2, v3
    v_lshl_add_u32 v45, v45, 4, v31
    v_lshlrev_b32 v243, 3, v45
    v_and_b32 v29, 31, v3
    v_lshrrev_b32 v30, 5, v3
    v_lshrrev_b32 v31, 3, v29
    v_xor_b32 v45, v31, v30
    v_and_b32 v45, 1, v45
    v_lshlrev_b32 v45, 4, v45
    v_lshl_add_u32 v45, v29, 5, v45
    ds_write_b128 v14, v[8:11] offset:24576
    v_add_u32 v241, s36, v45
    v_lshlrev_b32 v31, 5, v31
    v_lshl_add_u32 v31, v29, 7, v31
    v_lshrrev_b32 v29, 1, v29
    v_xor_b32 v29, v29, v30
    v_and_b32 v29, 1, v29
    v_lshl_add_u32 v31, v29, 4, v31
    v_add_u32 v240, s36, v31
    v_lshlrev_b32 v30, 6, v30
    s_lshl_b32 s61, s28, 14
    s_add_u32 s61, s61, 41984
    ds_write_b128 v14, v[8:11] offset:28672
    v_add_u32 v247, s61, v46
    v_and_b32 v29, 31, v3
    v_mul_u32_u24 v29, 144, v29
    v_add3_u32 v30, v30, v29, s61
    v_accvgpr_write_b32 a238, v30
    v_lshrrev_b32 v29, 3, v3
    v_lshlrev_b32 v246, 2, v29
    v_mul_u32_u24 v29, 144, v29
    v_and_b32 v239, 0x70, v5
    v_add3_u32 v238, v29, v239, s61
    v_accvgpr_write_b32 a237, v247
    ds_write_b128 v14, v[8:11] offset:32768
    s_waitcnt lgkmcnt(0)
    s_barrier
    s_waitcnt vmcnt(8)
    v_mul_hi_u32 v48, v16, s3
    v_lshl_add_u32 v81, v48, 2, s40
    ds_add_rtn_u32 v64, v81, v13
    v_mad_u32_u24 v81, v48, s37, 15
    v_lshrrev_b32 v81, 4, v81
    v_sub_u32 v16, v16, v81
    v_mul_hi_u32 v49, v17, s3
    v_lshl_add_u32 v83, v49, 2, s40
    ds_add_rtn_u32 v65, v83, v13
    v_mad_u32_u24 v83, v49, s37, 15
    v_lshrrev_b32 v83, 4, v83
    v_sub_u32 v17, v17, v83
    v_mul_hi_u32 v50, v18, s3
    v_lshl_add_u32 v85, v50, 2, s40
    ds_add_rtn_u32 v66, v85, v13
    v_mad_u32_u24 v85, v50, s37, 15
    v_lshrrev_b32 v85, 4, v85
    v_sub_u32 v18, v18, v85
    v_mul_hi_u32 v51, v19, s3
    v_lshl_add_u32 v87, v51, 2, s40
    ds_add_rtn_u32 v67, v87, v13
    v_mad_u32_u24 v87, v51, s37, 15
    v_lshrrev_b32 v87, 4, v87
    v_sub_u32 v19, v19, v87
    s_waitcnt vmcnt(7)
    v_mul_hi_u32 v52, v20, s3
    v_lshl_add_u32 v89, v52, 2, s40
    ds_add_rtn_u32 v68, v89, v13
    v_mad_u32_u24 v89, v52, s37, 15
    v_lshrrev_b32 v89, 4, v89
    v_sub_u32 v20, v20, v89
    v_mul_hi_u32 v53, v21, s3
    v_lshl_add_u32 v91, v53, 2, s40
    ds_add_rtn_u32 v69, v91, v13
    v_mad_u32_u24 v91, v53, s37, 15
    v_lshrrev_b32 v91, 4, v91
    v_sub_u32 v21, v21, v91
    v_mul_hi_u32 v54, v22, s3
    v_lshl_add_u32 v93, v54, 2, s40
    ds_add_rtn_u32 v70, v93, v13
    v_mad_u32_u24 v93, v54, s37, 15
    v_lshrrev_b32 v93, 4, v93
    v_sub_u32 v22, v22, v93
    v_mul_hi_u32 v55, v23, s3
    v_lshl_add_u32 v95, v55, 2, s40
    ds_add_rtn_u32 v71, v95, v13
    v_mad_u32_u24 v95, v55, s37, 15
    v_lshrrev_b32 v95, 4, v95
    v_sub_u32 v23, v23, v95
    s_waitcnt vmcnt(6)
    v_mul_hi_u32 v56, v24, s3
    v_lshl_add_u32 v97, v56, 2, s40
    ds_add_rtn_u32 v72, v97, v13
    v_mad_u32_u24 v97, v56, s37, 15
    v_lshrrev_b32 v97, 4, v97
    v_sub_u32 v24, v24, v97
    v_mul_hi_u32 v57, v25, s3
    v_lshl_add_u32 v99, v57, 2, s40
    ds_add_rtn_u32 v73, v99, v13
    v_mad_u32_u24 v99, v57, s37, 15
    v_lshrrev_b32 v99, 4, v99
    v_sub_u32 v25, v25, v99
    v_mul_hi_u32 v58, v26, s3
    v_lshl_add_u32 v101, v58, 2, s40
    ds_add_rtn_u32 v74, v101, v13
    v_mad_u32_u24 v101, v58, s37, 15
    v_lshrrev_b32 v101, 4, v101
    v_sub_u32 v26, v26, v101
    v_mul_hi_u32 v59, v27, s3
    v_lshl_add_u32 v103, v59, 2, s40
    ds_add_rtn_u32 v75, v103, v13
    v_mad_u32_u24 v103, v59, s37, 15
    v_lshrrev_b32 v103, 4, v103
    v_sub_u32 v27, v27, v103
    s_cmp_lg_u32 s28, 3
    s_cbranch_scc1 k2_notail1
    s_mov_b32 exec_hi, s33
    v_mul_hi_u32 v60, v28, s3
    v_lshl_add_u32 v105, v60, 2, s40
    ds_add_rtn_u32 v76, v105, v13
    v_mad_u32_u24 v105, v60, s37, 15
    v_lshrrev_b32 v105, 4, v105
    v_sub_u32 v28, v28, v105
    v_sub_u32 v105, 63, v60
    v_lshrrev_b32 v105, 5, v105
    v_lshlrev_b32 v105, 29, v105
    v_mad_u32_u24 v105, v44, s39, v105
    v_or_b32 v104, v104, v44
    v_alignbit_b32 v105, v28, v105, 30
    s_waitcnt lgkmcnt(0)
    v_min_u32 v76, 65816, v76
    v_mad_u32_u24 v60, v60, s38, v76
    ds_write_b64 v60, v[104:105]
    s_mov_b32 exec_hi, -1
k2_notail1:
    s_waitcnt vmcnt(0)
    v_readfirstlane_b32 s62, v234
    v_readfirstlane_b32 s63, v235
    global_load_dwordx4 v[160:163], v224, s[44:45] offset:-4096
    v_sub_u32 v81, 63, v48
    v_lshrrev_b32 v81, 5, v81
    v_lshlrev_b32 v81, 29, v81
    v_mad_u32_u24 v81, v32, s39, v81
    v_or_b32 v80, v80, v32
    v_alignbit_b32 v81, v16, v81, 30
    s_waitcnt lgkmcnt(11)
    v_min_u32 v64, 65816, v64
    v_mad_u32_u24 v48, v48, s38, v64
    ds_write_b64 v48, v[80:81]
    global_load_dwordx4 v[164:167], v224, s[44:45] offset:0
    v_sub_u32 v83, 63, v49
    v_lshrrev_b32 v83, 5, v83
    v_lshlrev_b32 v83, 29, v83
    v_mad_u32_u24 v83, v33, s39, v83
    v_or_b32 v82, v82, v33
    v_alignbit_b32 v83, v17, v83, 30
    s_waitcnt lgkmcnt(11)
    v_min_u32 v65, 65816, v65
    v_mad_u32_u24 v49, v49, s38, v65
    ds_write_b64 v49, v[82:83]
    global_load_dwordx4 v[168:171], v225, s[44:45] offset:-4096
    v_sub_u32 v85, 63, v50
    v_lshrrev_b32 v85, 5, v85
    v_lshlrev_b32 v85, 29, v85
    v_mad_u32_u24 v85, v34, s39, v85
    v_or_b32 v84, v84, v34
    v_alignbit_b32 v85, v18, v85, 30
    s_waitcnt lgkmcnt(11)
    v_min_u32 v66, 65816, v66
    v_mad_u32_u24 v50, v50, s38, v66
    ds_write_b64 v50, v[84:85]
    global_load_dwordx4 v[172:175], v225, s[44:45] offset:0
    v_sub_u32 v87, 63, v51
    v_lshrrev_b32 v87, 5, v87
    v_lshlrev_b32 v87, 29, v87
    v_mad_u32_u24 v87, v35, s39, v87
    v_or_b32 v86, v86, v35
    v_alignbit_b32 v87, v19, v87, 30
    s_waitcnt lgkmcnt(11)
    v_min_u32 v67, 65816, v67
    v_mad_u32_u24 v51, v51, s38, v67
    ds_write_b64 v51, v[86:87]
    global_load_dwordx4 v[176:179], v226, s[44:45] offset:-4096
    v_sub_u32 v89, 63, v52
    v_lshrrev_b32 v89, 5, v89
    v_lshlrev_b32 v89, 29, v89
    v_mad_u32_u24 v89, v36, s39, v89
    v_or_b32 v88, v88, v36
    v_alignbit_b32 v89, v20, v89, 30
    s_waitcnt lgkmcnt(11)
    v_min_u32 v68, 65816, v68
    v_mad_u32_u24 v52, v52, s38, v68
    ds_write_b64 v52, v[88:89]
    global_load_dwordx4 v[180:183], v226, s[44:45] offset:0
    v_sub_u32 v91, 63, v53
    v_lshrrev_b32 v91, 5, v91
    v_lshlrev_b32 v91, 29, v91
    v_mad_u32_u24 v91, v37, s39, v91
    v_or_b32 v90, v90, v37
    v_alignbit_b32 v91, v21, v91, 30
    s_waitcnt lgkmcnt(11)
    v_min_u32 v69, 65816, v69
    v_mad_u32_u24 v53, v53, s38, v69
    ds_write_b64 v53, v[90:91]
    global_load_dwordx4 v[184:187], v227, s[44:45] offset:-4096
    v_sub_u32 v93, 63, v54
    v_lshrrev_b32 v93, 5, v93
    v_lshlrev_b32 v93, 29, v93
    v_mad_u32_u24 v93, v38, s39, v93
    v_or_b32 v92, v92, v38
    v_alignbit_b32 v93, v22, v93, 30
    s_waitcnt lgkmcnt(11)
    v_min_u32 v70, 65816, v70
    v_mad_u32_u24 v54, v54, s38, v70
    ds_write_b64 v54, v[92:93]
    global_load_dwordx4 v[188:191], v227, s[44:45] offset:0
    v_sub_u32 v95, 63, v55
    v_lshrrev_b32 v95, 5, v95
    v_lshlrev_b32 v95, 29, v95
    v_mad_u32_u24 v95, v39, s39, v95
    v_or_b32 v94, v94, v39
    v_alignbit_b32 v95, v23, v95, 30
    s_waitcnt lgkmcnt(11)
    v_min_u32 v71, 65816, v71
    v_mad_u32_u24 v55, v55, s38, v71
    ds_write_b64 v55, v[94:95]
    global_load_dwordx4 v[192:195], v228, s[44:45] offset:-4096
    v_sub_u32 v97, 63, v56
    v_lshrrev_b32 v97, 5, v97
    v_lshlrev_b32 v97, 29, v97
    v_mad_u32_u24 v97, v40, s39, v97
    v_or_b32 v96, v96, v40
    v_alignbit_b32 v97, v24, v97, 30
    s_waitcnt lgkmcnt(11)
    v_min_u32 v72, 65816, v72
    v_mad_u32_u24 v56, v56, s38, v72
    ds_write_b64 v56, v[96:97]
    global_load_dwordx4 v[196:199], v224, s[48:49] offset:-4096
    v_sub_u32 v99, 63, v57
    v_lshrrev_b32 v99, 5, v99
    v_lshlrev_b32 v99, 29, v99
    v_mad_u32_u24 v99, v41, s39, v99
    v_or_b32 v98, v98, v41
    v_alignbit_b32 v99, v25, v99, 30
    s_waitcnt lgkmcnt(11)
    v_min_u32 v73, 65816, v73
    v_mad_u32_u24 v57, v57, s38, v73
    ds_write_b64 v57, v[98:99]
    global_load_dwordx4 v[200:203], v224, s[48:49] offset:0
    v_sub_u32 v101, 63, v58
    v_lshrrev_b32 v101, 5, v101
    v_lshlrev_b32 v101, 29, v101
    v_mad_u32_u24 v101, v42, s39, v101
    v_or_b32 v100, v100, v42
    v_alignbit_b32 v101, v26, v101, 30
    s_waitcnt lgkmcnt(11)
    v_min_u32 v74, 65816, v74
    v_mad_u32_u24 v58, v58, s38, v74
    ds_write_b64 v58, v[100:101]
    global_load_dwordx4 v[204:207], v225, s[48:49] offset:-4096
    v_sub_u32 v103, 63, v59
    v_lshrrev_b32 v103, 5, v103
    v_lshlrev_b32 v103, 29, v103
    v_mad_u32_u24 v103, v43, s39, v103
    v_or_b32 v102, v102, v43
    v_alignbit_b32 v103, v27, v103, 30
    s_waitcnt lgkmcnt(11)
    v_min_u32 v75, 65816, v75
    v_mad_u32_u24 v59, v59, s38, v75
    ds_write_b64 v59, v[102:103]
    global_load_dwordx4 v[208:211], v225, s[48:49] offset:0
    global_load_dwordx2 v[212:213], v229, s[46:47]
    global_load_ushort v214, v230, s[50:51]
    global_load_ushort v215, v230, s[50:51] offset:32
    s_add_u32 s99, s62, 1
    s_add_u32 s101, s63, 0x9e3779b1
    v_lshrrev_b32 v14, 2, v3
    v_and_b32 v1, 0xc0, v0
    v_add_u32 v1, v1, v14
    v_and_b32 v15, 3, v3
    v_mul_u32_u24 v2, 24, v15
    v_mad_u32_u24 v2, v1, s38, v2
    v_add_u32 v16, 65536, v2
    v_add_u32 v17, 70144, v2
    v_add_u32 v18, 74752, v2
    v_add_u32 v19, 79360, v2
    v_lshl_add_u32 v2, v1, 2, s40
    v_lshlrev_b32 v15, 4, v15
    v_and_b32 v14, 1, v1
    v_lshrrev_b32 v1, 1, v1
    v_mul_u32_u24 v1, 98432, v1
    v_add3_u32 v1, v1, v15, s60
    v_lshl_add_u32 v12, v14, 6, v1
    v_lshl_add_u32 v1, v14, 14, v1
    v_add_u32 v14, s60, v12
    s_waitcnt lgkmcnt(0)
    s_barrier
    ds_read2_b64 v[112:115], v16 offset0:0 offset1:1
    ds_read_b64 v[116:117], v16 offset:16
    ds_read2_b64 v[118:121], v17 offset0:0 offset1:1
    ds_read_b64 v[122:123], v17 offset:16
    ds_read2_b64 v[124:127], v18 offset0:0 offset1:1
    ds_read_b64 v[128:129], v18 offset:16
    ds_read2_b64 v[130:133], v19 offset0:0 offset1:1
    ds_read_b64 v[134:135], v19 offset:16
    ds_read_b32 v12, v7
    ds_read2_b32 v[108:109], v2 offset0:0 offset1:16
    ds_read2_b32 v[110:111], v2 offset0:32 offset1:48
    ds_read2_b64 v[136:139], v16 offset0:12 offset1:13
    ds_read_b64 v[140:141], v16 offset:112
    s_waitcnt lgkmcnt(11)
    v_lshl_or_b32 v113, v115, 10, v113
    v_mov_b32 v115, v116
    v_lshl_or_b32 v113, v117, 20, v113
    s_mov_b32 s59, 0
    buffer_store_dwordx4 v[112:115], v1, s[20:23], s59 offen sc1
    ds_read2_b64 v[142:145], v17 offset0:12 offset1:13
    ds_read_b64 v[146:147], v17 offset:112
    s_waitcnt lgkmcnt(11)
    v_lshl_or_b32 v119, v121, 10, v119
    v_mov_b32 v121, v122
    v_lshl_or_b32 v119, v123, 20, v119
    s_mov_b32 s59, 787456
    buffer_store_dwordx4 v[118:121], v1, s[20:23], s59 offen sc1
    ds_read2_b64 v[148:151], v18 offset0:12 offset1:13
    ds_read_b64 v[152:153], v18 offset:112
    s_waitcnt lgkmcnt(11)
    v_lshl_or_b32 v125, v127, 10, v125
    v_mov_b32 v127, v128
    v_lshl_or_b32 v125, v129, 20, v125
    s_mov_b32 s59, 1574912
    buffer_store_dwordx4 v[124:127], v1, s[20:23], s59 offen sc1
    ds_read2_b64 v[154:157], v19 offset0:12 offset1:13
    ds_read_b64 v[158:159], v19 offset:112
    s_waitcnt lgkmcnt(11)
    v_lshl_or_b32 v131, v133, 10, v131
    v_mov_b32 v133, v134
    v_lshl_or_b32 v131, v135, 20, v131
    s_mov_b32 s59, 2362368
    buffer_store_dwordx4 v[130:133], v1, s[20:23], s59 offen sc1
    s_waitcnt vmcnt(4) lgkmcnt(8)
    v_cmp_lt_u32 vcc, 65632, v12
    s_mov_b64 s[52:53], vcc
    v_cmp_lt_u32 vcc, 65728, v12
    s_mov_b64 s[56:57], vcc
    v_cmp_lt_u32 vcc, 65824, v12
    s_andn2_b64 s[52:53], s[52:53], vcc
    v_max_u32_dpp v108, v108, v108 row_half_mirror row_mask:0xf bank_mask:0xf
    v_max_u32_dpp v109, v109, v109 row_half_mirror row_mask:0xf bank_mask:0xf
    v_max_u32_dpp v110, v110, v110 row_half_mirror row_mask:0xf bank_mask:0xf
    v_max_u32_dpp v111, v111, v111 row_half_mirror row_mask:0xf bank_mask:0xf
    v_cmp_lt_u32 vcc, 65632, v108
    s_waitcnt lgkmcnt(6)
    v_lshl_or_b32 v137, v139, 10, v137
    v_mov_b32 v139, v140
    v_lshl_or_b32 v137, v141, 20, v137
    s_mov_b64 exec, vcc
    s_mov_b32 s59, 32768
    buffer_store_dwordx4 v[136:139], v14, s[20:23], s59 offen sc1
    s_mov_b64 exec, -1
    v_cmp_lt_u32 vcc, 65632, v109
    s_waitcnt lgkmcnt(4)
    v_lshl_or_b32 v143, v145, 10, v143
    v_mov_b32 v145, v146
    v_lshl_or_b32 v143, v147, 20, v143
    s_mov_b64 exec, vcc
    s_mov_b32 s59, 820224
    buffer_store_dwordx4 v[142:145], v14, s[20:23], s59 offen sc1
    s_mov_b64 exec, -1
    v_cmp_lt_u32 vcc, 65632, v110
    s_waitcnt lgkmcnt(2)
    v_lshl_or_b32 v149, v151, 10, v149
    v_mov_b32 v151, v152
    v_lshl_or_b32 v149, v153, 20, v149
    s_mov_b64 exec, vcc
    s_mov_b32 s59, 1607680
    buffer_store_dwordx4 v[148:151], v14, s[20:23], s59 offen sc1
    s_mov_b64 exec, -1
    v_cmp_lt_u32 vcc, 65632, v111
    s_waitcnt lgkmcnt(0)
    v_lshl_or_b32 v155, v157, 10, v155
    v_mov_b32 v157, v158
    v_lshl_or_b32 v155, v159, 20, v155
    s_mov_b64 exec, vcc
    s_mov_b32 s59, 2395136
    buffer_store_dwordx4 v[154:157], v14, s[20:23], s59 offen sc1
    s_mov_b64 exec, -1
    s_cmp_eq_u64 s[56:57], 0
    s_cbranch_scc1 k2_b_no3
    ds_read2_b64 v[112:115], v16 offset0:24 offset1:25
    ds_read_b64 v[116:117], v16 offset:208
    ds_read2_b64 v[118:121], v17 offset0:24 offset1:25
    ds_read_b64 v[122:123], v17 offset:208
    ds_read2_b64 v[124:127], v18 offset0:24 offset1:25
    ds_read_b64 v[128:129], v18 offset:208
    ds_read2_b64 v[130:133], v19 offset0:24 offset1:25
    ds_read_b64 v[134:135], v19 offset:208
    s_waitcnt lgkmcnt(0)
    v_lshl_or_b32 v113, v115, 10, v113
    v_mov_b32 v115, v116
    v_lshl_or_b32 v113, v117, 20, v113
    s_mov_b32 s59, 65536
    buffer_store_dwordx4 v[112:115], v14, s[20:23], s59 offen sc1
    v_lshl_or_b32 v119, v121, 10, v119
    v_mov_b32 v121, v122
    v_lshl_or_b32 v119, v123, 20, v119
    s_mov_b32 s59, 852992
    buffer_store_dwordx4 v[118:121], v14, s[20:23], s59 offen sc1
    v_lshl_or_b32 v125, v127, 10, v125
    v_mov_b32 v127, v128
    v_lshl_or_b32 v125, v129, 20, v125
    s_mov_b32 s59, 1640448
    buffer_store_dwordx4 v[124:127], v14, s[20:23], s59 offen sc1
    v_lshl_or_b32 v131, v133, 10, v131
    v_mov_b32 v133, v134
    v_lshl_or_b32 v131, v135, 20, v131
    s_mov_b32 s59, 2427904
    buffer_store_dwordx4 v[130:133], v14, s[20:23], s59 offen sc1
k2_b_no3:
    s_mov_b32 s44, 3216550459
    s_mov_b32 s45, 3216550459
    v_and_b32 v2, 0xf0, v5
    v_lshrrev_b32 v1, 4, v0
    v_mul_u32_u24 v1, 320, v1
    v_add_u32 v2, v1, v2
    v_and_b32 v4, 0x3f0, v5
    ds_write_b128 v5, v[196:199] offset:46080
    v_lshlrev_b32 v216, 16, v160
    v_and_b32 v217, 0xffff0000, v160
    v_pk_mul_f32 v[216:217], v[216:217], s[44:45]
    v_lshlrev_b32 v218, 16, v161
    v_and_b32 v219, 0xffff0000, v161
    v_pk_mul_f32 v[218:219], v[218:219], s[44:45]
    v_lshlrev_b32 v220, 16, v162
    v_and_b32 v221, 0xffff0000, v162
    v_pk_mul_f32 v[220:221], v[220:221], s[44:45]
    v_lshlrev_b32 v222, 16, v163
    v_and_b32 v223, 0xffff0000, v163
    v_pk_mul_f32 v[222:223], v[222:223], s[44:45]
    v_cvt_pk_bf16_f32 v160, v216, v217
    v_cvt_pk_bf16_f32 v161, v218, v219
    v_cvt_pk_bf16_f32 v162, v220, v221
    v_cvt_pk_bf16_f32 v163, v222, v223
    ds_write_b128 v2, v[160:163] offset:0
    ds_write_b128 v5, v[200:203] offset:50176
    v_lshlrev_b32 v216, 16, v164
    v_and_b32 v217, 0xffff0000, v164
    v_pk_mul_f32 v[216:217], v[216:217], s[44:45]
    v_lshlrev_b32 v218, 16, v165
    v_and_b32 v219, 0xffff0000, v165
    v_pk_mul_f32 v[218:219], v[218:219], s[44:45]
    v_lshlrev_b32 v220, 16, v166
    v_and_b32 v221, 0xffff0000, v166
    v_pk_mul_f32 v[220:221], v[220:221], s[44:45]
    v_lshlrev_b32 v222, 16, v167
    v_and_b32 v223, 0xffff0000, v167
    v_pk_mul_f32 v[222:223], v[222:223], s[44:45]
    v_cvt_pk_bf16_f32 v164, v216, v217
    v_cvt_pk_bf16_f32 v165, v218, v219
    v_cvt_pk_bf16_f32 v166, v220, v221
    v_cvt_pk_bf16_f32 v167, v222, v223
    ds_write_b128 v2, v[164:167] offset:5120
    ds_write_b128 v5, v[204:207] offset:54272
    v_lshlrev_b32 v216, 16, v168
    v_and_b32 v217, 0xffff0000, v168
    v_pk_mul_f32 v[216:217], v[216:217], s[44:45]
    v_lshlrev_b32 v218, 16, v169
    v_and_b32 v219, 0xffff0000, v169
    v_pk_mul_f32 v[218:219], v[218:219], s[44:45]
    v_lshlrev_b32 v220, 16, v170
    v_and_b32 v221, 0xffff0000, v170
    v_pk_mul_f32 v[220:221], v[220:221], s[44:45]
    v_lshlrev_b32 v222, 16, v171
    v_and_b32 v223, 0xffff0000, v171
    v_pk_mul_f32 v[222:223], v[222:223], s[44:45]
    v_cvt_pk_bf16_f32 v168, v216, v217
    v_cvt_pk_bf16_f32 v169, v218, v219
    v_cvt_pk_bf16_f32 v170, v220, v221
    v_cvt_pk_bf16_f32 v171, v222, v223
    ds_write_b128 v2, v[168:171] offset:10240
    ds_write_b128 v5, v[208:211] offset:58368
    v_lshlrev_b32 v216, 16, v172
    v_and_b32 v217, 0xffff0000, v172
    v_pk_mul_f32 v[216:217], v[216:217], s[44:45]
    v_lshlrev_b32 v218, 16, v173
    v_and_b32 v219, 0xffff0000, v173
    v_pk_mul_f32 v[218:219], v[218:219], s[44:45]
    v_lshlrev_b32 v220, 16, v174
    v_and_b32 v221, 0xffff0000, v174
    v_pk_mul_f32 v[220:221], v[220:221], s[44:45]
    v_lshlrev_b32 v222, 16, v175
    v_and_b32 v223, 0xffff0000, v175
    v_pk_mul_f32 v[222:223], v[222:223], s[44:45]
    v_cvt_pk_bf16_f32 v172, v216, v217
    v_cvt_pk_bf16_f32 v173, v218, v219
    v_cvt_pk_bf16_f32 v174, v220, v221
    v_cvt_pk_bf16_f32 v175, v222, v223
    ds_write_b128 v2, v[172:175] offset:15360
    v_lshlrev_b32 v216, 16, v176
    v_and_b32 v217, 0xffff0000, v176
    v_pk_mul_f32 v[216:217], v[216:217], s[44:45]
    v_lshlrev_b32 v218, 16, v177
    v_and_b32 v219, 0xffff0000, v177
    v_pk_mul_f32 v[218:219], v[218:219], s[44:45]
    v_lshlrev_b32 v220, 16, v178
    v_and_b32 v221, 0xffff0000, v178
    v_pk_mul_f32 v[220:221], v[220:221], s[44:45]
    v_lshlrev_b32 v222, 16, v179
    v_and_b32 v223, 0xffff0000, v179
    v_pk_mul_f32 v[222:223], v[222:223], s[44:45]
    v_cvt_pk_bf16_f32 v176, v216, v217
    v_cvt_pk_bf16_f32 v177, v218, v219
    v_cvt_pk_bf16_f32 v178, v220, v221
    v_cvt_pk_bf16_f32 v179, v222, v223
    ds_write_b128 v2, v[176:179] offset:20480
    v_lshlrev_b32 v216, 16, v180
    v_and_b32 v217, 0xffff0000, v180
    v_pk_mul_f32 v[216:217], v[216:217], s[44:45]
    v_lshlrev_b32 v218, 16, v181
    v_and_b32 v219, 0xffff0000, v181
    v_pk_mul_f32 v[218:219], v[218:219], s[44:45]
    v_lshlrev_b32 v220, 16, v182
    v_and_b32 v221, 0xffff0000, v182
    v_pk_mul_f32 v[220:221], v[220:221], s[44:45]
    v_lshlrev_b32 v222, 16, v183
    v_and_b32 v223, 0xffff0000, v183
    v_pk_mul_f32 v[222:223], v[222:223], s[44:45]
    v_cvt_pk_bf16_f32 v180, v216, v217
    v_cvt_pk_bf16_f32 v181, v218, v219
    v_cvt_pk_bf16_f32 v182, v220, v221
    v_cvt_pk_bf16_f32 v183, v222, v223
    ds_write_b128 v2, v[180:183] offset:25600
    v_lshlrev_b32 v216, 16, v184
    v_and_b32 v217, 0xffff0000, v184
    v_pk_mul_f32 v[216:217], v[216:217], s[44:45]
    v_lshlrev_b32 v218, 16, v185
    v_and_b32 v219, 0xffff0000, v185
    v_pk_mul_f32 v[218:219], v[218:219], s[44:45]
    v_lshlrev_b32 v220, 16, v186
    v_and_b32 v221, 0xffff0000, v186
    v_pk_mul_f32 v[220:221], v[220:221], s[44:45]
    v_lshlrev_b32 v222, 16, v187
    v_and_b32 v223, 0xffff0000, v187
    v_pk_mul_f32 v[222:223], v[222:223], s[44:45]
    v_cvt_pk_bf16_f32 v184, v216, v217
    v_cvt_pk_bf16_f32 v185, v218, v219
    v_cvt_pk_bf16_f32 v186, v220, v221
    v_cvt_pk_bf16_f32 v187, v222, v223
    ds_write_b128 v2, v[184:187] offset:30720
    v_and_b32 v1, 32, v0
    v_lshrrev_b64 v[16:17], v1, s[52:53]
    v_lshrrev_b64 v[20:21], v1, s[56:57]
    v_mov_b32 v18, s99
    v_mov_b32 v19, s101
    v_mov_b32 v17, v20
    v_lshrrev_b32 v1, 5, v0
    v_lshlrev_b32 v1, 12, v1
    s_lshl_b32 s60, s2, 4
    s_add_u32 s60, s60, 65536
    s_mov_b32 exec_lo, 1
    s_mov_b32 exec_hi, 1
    s_waitcnt vmcnt(0)
    buffer_store_dwordx4 v[16:19], v1, s[24:27], s60 offen sc1
    s_mov_b64 exec, -1
    v_lshlrev_b32 v216, 16, v188
    v_and_b32 v217, 0xffff0000, v188
    v_pk_mul_f32 v[216:217], v[216:217], s[44:45]
    v_lshlrev_b32 v218, 16, v189
    v_and_b32 v219, 0xffff0000, v189
    v_pk_mul_f32 v[218:219], v[218:219], s[44:45]
    v_lshlrev_b32 v220, 16, v190
    v_and_b32 v221, 0xffff0000, v190
    v_pk_mul_f32 v[220:221], v[220:221], s[44:45]
    v_lshlrev_b32 v222, 16, v191
    v_and_b32 v223, 0xffff0000, v191
    v_pk_mul_f32 v[222:223], v[222:223], s[44:45]
    v_cvt_pk_bf16_f32 v188, v216, v217
    v_cvt_pk_bf16_f32 v189, v218, v219
    v_cvt_pk_bf16_f32 v190, v220, v221
    v_cvt_pk_bf16_f32 v191, v222, v223
    ds_write_b128 v2, v[188:191] offset:35840
    v_lshlrev_b32 v216, 16, v192
    v_and_b32 v217, 0xffff0000, v192
    v_pk_mul_f32 v[216:217], v[216:217], s[44:45]
    v_lshlrev_b32 v218, 16, v193
    v_and_b32 v219, 0xffff0000, v193
    v_pk_mul_f32 v[218:219], v[218:219], s[44:45]
    v_lshlrev_b32 v220, 16, v194
    v_and_b32 v221, 0xffff0000, v194
    v_pk_mul_f32 v[220:221], v[220:221], s[44:45]
    v_lshlrev_b32 v222, 16, v195
    v_and_b32 v223, 0xffff0000, v195
    v_pk_mul_f32 v[222:223], v[222:223], s[44:45]
    v_cvt_pk_bf16_f32 v192, v216, v217
    v_cvt_pk_bf16_f32 v193, v218, v219
    v_cvt_pk_bf16_f32 v194, v220, v221
    v_cvt_pk_bf16_f32 v195, v222, v223
    ds_write_b128 v2, v[192:195] offset:40960
    v_lshlrev_b32 v216, 16, v212
    v_and_b32 v217, 0xffff0000, v212
    v_lshlrev_b32 v218, 16, v213
    v_and_b32 v219, 0xffff0000, v213
    v_pk_mul_f32 v[216:217], v[216:217], s[44:45]
    v_pk_mul_f32 v[218:219], v[218:219], s[44:45]
    v_add_u32 v1, 158720, v4
    ds_write_b128 v1, v[216:219]
    v_add_u32 v7, 107520, v5
    s_waitcnt lgkmcnt(0)
    s_barrier
    ds_read_b64_tr_b16 a[0:1], v248 offset:0
    ds_read_b64_tr_b16 a[2:3], v248 offset:1280
    ds_read_b64_tr_b16 a[4:5], v248 offset:5120
    ds_read_b64_tr_b16 a[6:7], v248 offset:6400
    ds_read_b64_tr_b16 a[8:9], v248 offset:10240
    ds_read_b64_tr_b16 a[10:11], v248 offset:11520
    ds_read_b64_tr_b16 a[12:13], v248 offset:15360
    ds_read_b64_tr_b16 a[14:15], v248 offset:16640
    ds_read_b64_tr_b16 a[80:81], v248 offset:20480
    ds_read_b64_tr_b16 a[82:83], v248 offset:21760
    ds_read_b64_tr_b16 a[84:85], v248 offset:25600
    ds_read_b64_tr_b16 a[86:87], v248 offset:26880
    ds_read_b64_tr_b16 a[88:89], v248 offset:30720
    ds_read_b64_tr_b16 a[90:91], v248 offset:32000
    ds_read_b64_tr_b16 a[92:93], v248 offset:35840
    ds_read_b64_tr_b16 a[94:95], v248 offset:37120
    ds_read_b64_tr_b16 a[16:17], v248 offset:40960
    ds_read_b64_tr_b16 a[18:19], v248 offset:42240
    ds_read_b64_tr_b16 a[20:21], v248 offset:64
    ds_read_b64_tr_b16 a[22:23], v248 offset:1344
    ds_read_b64_tr_b16 a[24:25], v248 offset:5184
    ds_read_b64_tr_b16 a[26:27], v248 offset:6464
    ds_read_b64_tr_b16 a[28:29], v248 offset:10304
    ds_read_b64_tr_b16 a[30:31], v248 offset:11584
    ds_read_b64_tr_b16 a[32:33], v248 offset:15424
    ds_read_b64_tr_b16 a[34:35], v248 offset:16704
    ds_read_b64_tr_b16 a[96:97], v248 offset:20544
    ds_read_b64_tr_b16 a[98:99], v248 offset:21824
    ds_read_b64_tr_b16 a[100:101], v248 offset:25664
    ds_read_b64_tr_b16 a[102:103], v248 offset:26944
    ds_read_b64_tr_b16 a[104:105], v248 offset:30784
    ds_read_b64_tr_b16 a[106:107], v248 offset:32064
    ds_read_b64_tr_b16 a[108:109], v248 offset:35904
    ds_read_b64_tr_b16 a[110:111], v248 offset:37184
    ds_read_b64_tr_b16 a[36:37], v248 offset:41024
    ds_read_b64_tr_b16 a[38:39], v248 offset:42304
    ds_read_b64_tr_b16 a[40:41], v248 offset:128
    ds_read_b64_tr_b16 a[42:43], v248 offset:1408
    ds_read_b64_tr_b16 a[44:45], v248 offset:5248
    ds_read_b64_tr_b16 a[46:47], v248 offset:6528
    ds_read_b64_tr_b16 a[48:49], v248 offset:10368
    ds_read_b64_tr_b16 a[50:51], v248 offset:11648
    ds_read_b64_tr_b16 a[52:53], v248 offset:15488
    ds_read_b64_tr_b16 a[54:55], v248 offset:16768
    ds_read_b64_tr_b16 a[112:113], v248 offset:20608
    ds_read_b64_tr_b16 a[114:115], v248 offset:21888
    ds_read_b64_tr_b16 a[116:117], v248 offset:25728
    ds_read_b64_tr_b16 a[118:119], v248 offset:27008
    ds_read_b64_tr_b16 a[120:121], v248 offset:30848
    ds_read_b64_tr_b16 a[122:123], v248 offset:32128
    ds_read_b64_tr_b16 a[124:125], v248 offset:35968
    ds_read_b64_tr_b16 a[126:127], v248 offset:37248
    ds_read_b64_tr_b16 a[56:57], v248 offset:41088
    ds_read_b64_tr_b16 a[58:59], v248 offset:42368
    ds_read_b64_tr_b16 a[60:61], v248 offset:192
    ds_read_b64_tr_b16 a[62:63], v248 offset:1472
    ds_read_b64_tr_b16 a[64:65], v248 offset:5312
    ds_read_b64_tr_b16 a[66:67], v248 offset:6592
    ds_read_b64_tr_b16 a[68:69], v248 offset:10432
    ds_read_b64_tr_b16 a[70:71], v248 offset:11712
    ds_read_b64_tr_b16 a[72:73], v248 offset:15552
    ds_read_b64_tr_b16 a[74:75], v248 offset:16832
    ds_read_b64_tr_b16 a[128:129], v248 offset:20672
    ds_read_b64_tr_b16 a[130:131], v248 offset:21952
    ds_read_b64_tr_b16 a[132:133], v248 offset:25792
    ds_read_b64_tr_b16 a[134:135], v248 offset:27072
    ds_read_b64_tr_b16 a[136:137], v248 offset:30912
    ds_read_b64_tr_b16 a[138:139], v248 offset:32192
    ds_read_b64_tr_b16 a[140:141], v248 offset:36032
    ds_read_b64_tr_b16 a[142:143], v248 offset:37312
    ds_read_b64_tr_b16 a[76:77], v248 offset:41152
    ds_read_b64_tr_b16 a[78:79], v248 offset:42432
    ds_read_b64_tr_b16 a[144:145], v249 offset:46080
    ds_read_b64_tr_b16 a[146:147], v249 offset:47104
    ds_read_b64_tr_b16 a[148:149], v249 offset:46112
    ds_read_b64_tr_b16 a[150:151], v249 offset:47136
    ds_read_b64_tr_b16 a[152:153], v249 offset:48128
    ds_read_b64_tr_b16 a[154:155], v249 offset:49152
    ds_read_b64_tr_b16 a[156:157], v249 offset:48160
    ds_read_b64_tr_b16 a[158:159], v249 offset:49184
    ds_read_b64_tr_b16 a[160:161], v249 offset:50176
    ds_read_b64_tr_b16 a[162:163], v249 offset:51200
    ds_read_b64_tr_b16 a[164:165], v249 offset:50208
    ds_read_b64_tr_b16 a[166:167], v249 offset:51232
    ds_read_b64_tr_b16 a[168:169], v249 offset:52224
    ds_read_b64_tr_b16 a[170:171], v249 offset:53248
    ds_read_b64_tr_b16 a[172:173], v249 offset:52256
    ds_read_b64_tr_b16 a[174:175], v249 offset:53280
    ds_read_b64_tr_b16 a[176:177], v249 offset:54272
    ds_read_b64_tr_b16 a[178:179], v249 offset:55296
    ds_read_b64_tr_b16 a[180:181], v249 offset:54304
    ds_read_b64_tr_b16 a[182:183], v249 offset:55328
    ds_read_b64_tr_b16 a[184:185], v249 offset:56320
    ds_read_b64_tr_b16 a[186:187], v249 offset:57344
    ds_read_b64_tr_b16 a[188:189], v249 offset:56352
    ds_read_b64_tr_b16 a[190:191], v249 offset:57376
    ds_read_b64_tr_b16 a[192:193], v249 offset:58368
    ds_read_b64_tr_b16 a[194:195], v249 offset:59392
    ds_read_b64_tr_b16 a[196:197], v249 offset:58400
    ds_read_b64_tr_b16 a[198:199], v249 offset:59424
    ds_read_b64_tr_b16 a[200:201], v249 offset:60416
    ds_read_b64_tr_b16 a[202:203], v249 offset:61440
    ds_read_b64_tr_b16 a[204:205], v249 offset:60448
    ds_read_b64_tr_b16 a[206:207], v249 offset:61472
    s_lshr_b32 s56, s29, 1
    s_mul_i32 s56, s56, 98432
    s_add_u32 s56, s56, 16777216
    s_add_u32 s20, s24, s56
    s_addc_u32 s21, s25, 0
    s_mov_b32 s22, 98304
    s_lshl_b32 s56, s29, 7
    s_and_b32 s56, s56, 0x7000
    s_add_u32 s56, s56, 65536
    s_movk_i32 s57, 4000
    s_and_b32 s59, s29, 1
    s_lshl_b32 s58, s59, 2
    s_add_u32 s58, s58, s28
    s_lshl_b32 s58, s58, 12
    s_lshl_b32 s59, s59, 6
    s_add_u32 s59, s59, 32768
    v_lshl_add_u32 v1, v0, 7, s59
    v_lshrrev_b32 v2, 2, v3
    v_lshl_add_u32 v14, v2, 2, s41
    v_and_b32 v136, 0xc0, v0
    v_add_u32 v136, v136, v2
    v_mul_u32_u24 v136, s37, v136
    v_add_u32 v139, 150000, v136
    v_and_b32 v139, 0xffffffe0, v139
    v_add_u32 v138, 100000, v136
    v_and_b32 v138, 0xffffffe0, v138
    v_add_u32 v137, 50000, v136
    v_and_b32 v137, 0xffffffe0, v137
    v_and_b32 v136, 0xffffffe0, v136
    v_mov_b32 v33, -1
    v_mov_b32 v37, -1
    v_mov_b32 v41, -1
    v_mov_b32 v45, -1
    s_mov_b32 s62, 1
k2_poll:
    buffer_load_dwordx4 v[128:131], v5, s[24:27], s56 offen sc1
    s_sub_u32 s57, s57, 1
    s_cbranch_scc1 k2_giveup
    s_waitcnt vmcnt(0)
    v_cmp_ne_u32 vcc, s99, v130
    v_cmp_ne_u32 s[46:47], s101, v131
    s_or_b64 vcc, vcc, s[46:47]
    s_cbranch_scc1 k2_poll
    s_barrier
    buffer_load_dwordx4 v[16:19], v4, s[20:23], s58 offen offset:0 sc1
    buffer_load_dwordx4 v[20:23], v4, s[20:23], s58 offen offset:1024 sc1
    buffer_load_dwordx4 v[24:27], v4, s[20:23], s58 offen offset:2048 sc1
    buffer_load_dwordx4 v[28:31], v4, s[20:23], s58 offen offset:3072 sc1
    v_and_b32 v128, s32, v128
    v_and_b32 v129, s32, v129
    v_cmp_ne_u32 s[46:47], 0, v128
    v_cmp_ne_u32 s[56:57], 0, v129
    s_nop 0
    v_mbcnt_lo_u32_b32 v128, s46, 0
    v_mbcnt_hi_u32_b32 v128, s47, v128
    s_bcnt1_i32_b64 s60, s[46:47]
    s_andn2_b64 s[52:53], s[56:57], s[46:47]
    v_lshl_add_u32 v128, v128, 2, s41
    s_mov_b64 exec, s[46:47]
    ds_write_b32 v128, v1
    s_mov_b64 exec, s[56:57]
    s_cbranch_execz k2_no3
    v_mbcnt_lo_u32_b32 v129, s56, 0
    v_mbcnt_hi_u32_b32 v129, s57, v129
    v_add_u32 v129, s60, v129
    v_lshl_add_u32 v129, v129, 2, s41
    v_add_u32 v1, 32768, v1
    s_bcnt1_i32_b64 s61, s[56:57]
    ds_write_b32 v129, v1
    s_add_u32 s60, s60, s61
k2_no3:
    s_mov_b64 exec, -1
    ds_read2_b32 v[132:133], v14 offset0:0 offset1:16
    ds_read2_b32 v[134:135], v14 offset0:32 offset1:48
    v_sub_u32 v2, s60, v2
    s_cmp_gt_u32 s60, 64
    s_cselect_b64 s[52:53], -1, s[52:53]
    s_cmp_lg_u64 s[52:53], 0
    s_cbranch_scc1 k2_drop
    s_add_u32 s60, s60, 15
    s_lshr_b32 s60, s60, 4
    s_add_u32 s60, s60, 4
    s_waitcnt lgkmcnt(0)
    v_cmpx_lt_i32 vcc, 0, v2
    v_add_u32 v132, v132, v15
    s_cbranch_execz k2_ld_done
    buffer_load_dwordx4 v[32:35], v132, s[20:23], 0 offen sc1
    v_cmpx_lt_i32 vcc, 16, v2
    v_add_u32 v133, v133, v15
    s_cbranch_execz k2_ld_done
    buffer_load_dwordx4 v[36:39], v133, s[20:23], 0 offen sc1
    v_cmpx_lt_i32 vcc, 32, v2
    v_add_u32 v134, v134, v15
    s_cbranch_execz k2_ld_done
    buffer_load_dwordx4 v[40:43], v134, s[20:23], 0 offen sc1
    v_cmpx_lt_i32 vcc, 48, v2
    v_add_u32 v135, v135, v15
    s_cbranch_execz k2_ld_done
    buffer_load_dwordx4 v[44:47], v135, s[20:23], 0 offen sc1
k2_ld_done:
    s_mov_b64 exec, -1
    ds_write_b128 v7, v[8:11] offset:0
    v_lshlrev_b32 v214, 16, v214
    v_lshlrev_b32 v215, 16, v215
    v_pk_mul_f32 v[214:215], v[214:215], s[44:45]
    v_cmp_gt_u32 vcc, 32, v3
    v_cvt_pk_bf16_f32 v220, v214, v215
    ds_write_b128 v7, v[8:11] offset:4096
    v_and_b32 v221, 0xffff0000, v220
    v_lshlrev_b32 v220, 16, v220
    v_sub_f32 v214, v214, v220
    v_sub_f32 v215, v215, v221
    v_cvt_pk_bf16_f32 v220, v220, v214
    ds_write_b128 v7, v[8:11] offset:8192
    v_cvt_pk_bf16_f32 v221, v221, v215
    v_cndmask_b32 v220, 0, v220, vcc
    v_cndmask_b32 v221, 0, v221, vcc
    v_accvgpr_write_b32 a208, v220
    v_accvgpr_write_b32 a212, v221
    ds_write_b128 v7, v[8:11] offset:12288
    s_mov_b32 s33, 3168
    s_mov_b32 s44, 3207688728
    s_mov_b32 s45, 3207688728
    s_mov_b32 s48, 0x7b800000
    s_mov_b32 s3, 160256
    ds_write_b128 v7, v[8:11] offset:16384
    v_lshlrev_b32 v12, 2, v3
    v_add_u32 v12, 163392, v12
    v_mov_b32 v13, 1
    v_mov_b32 v219, v255
    v_mov_b32 v221, v255
    ds_write_b128 v7, v[8:11] offset:20480
    v_mov_b32 v223, v255
    v_mov_b32 v225, v255
    v_mov_b32 v227, v254
    v_mov_b32 v229, v255
    v_mov_b32 v231, v255
    ds_write_b128 v7, v[8:11] offset:24576
    v_mov_b32 v233, v255
    v_mov_b32 v235, v255
    v_mov_b32 v237, v254
    v_bfe_u32 v140, v132, 7, 8
    v_mul_u32_u24 v140, s37, v140
    ds_write_b128 v7, v[8:11] offset:28672
    v_and_b32 v140, 0xffffffe0, v140
    v_bfe_u32 v141, v133, 7, 8
    v_mul_u32_u24 v141, s37, v141
    v_and_b32 v141, 0xffffffe0, v141
    v_bfe_u32 v142, v134, 7, 8
    ds_write_b128 v7, v[8:11] offset:32768
    v_mul_u32_u24 v142, s37, v142
    v_and_b32 v142, 0xffffffe0, v142
    v_bfe_u32 v143, v135, 7, 8
    v_mul_u32_u24 v143, s37, v143
    v_and_b32 v143, 0xffffffe0, v143
    ds_write_b128 v7, v[8:11] offset:36864
    ds_write_b128 v7, v[8:11] offset:40960
    ds_write_b128 v7, v[8:11] offset:45056
    ds_read_b128 v[144:147], v250 offset:0
    ds_read_b128 v[148:151], v250 offset:16
    ds_read_b128 v[152:155], v250 offset:32
    ds_read_b128 v[156:159], v250 offset:48
    ds_read_b128 v[160:163], v250 offset:64
    ds_read_b128 v[164:167], v250 offset:80
    ds_read_b128 v[168:171], v250 offset:96
    ds_read_b128 v[172:175], v250 offset:112
    ds_read_b128 v[176:179], v250 offset:128
    ds_read_b128 v[180:183], v250 offset:144
    ds_read_b128 v[184:187], v250 offset:160
    ds_read_b128 v[188:191], v250 offset:176
    ds_read_b128 v[192:195], v250 offset:192
    ds_read_b128 v[196:199], v250 offset:208
    ds_read_b128 v[200:203], v250 offset:224
    ds_read_b128 v[204:207], v250 offset:240
    s_mov_b32 s37, s62
    s_cmp_ge_u32 s60, 6
    s_cbranch_scc1 k2_two
    s_waitcnt vmcnt(0)
k2_two:
    s_waitcnt vmcnt(5)
    v_bfe_u32 v64, v17, 0, 10
    v_lshl_add_u32 v64, v64, 2, s3
    ds_add_rtn_u32 v88, v64, v13
    v_bfe_u32 v65, v17, 10, 10
    v_lshl_add_u32 v65, v65, 2, s3
    ds_add_rtn_u32 v89, v65, v13
    v_bfe_u32 v66, v17, 20, 10
    v_lshl_add_u32 v66, v66, 2, s3
    ds_add_rtn_u32 v90, v66, v13
    v_mov_b32 v48, v19
    v_mad_u32_u16 v49, v48, 1, v136 op_sel:[1,0,0,0]
    v_mad_u32_u16 v17, v16, 1, v136 op_sel:[1,0,0,0]
    v_mad_u32_u16 v19, v18, 1, v136 op_sel:[1,0,0,0]
    s_waitcnt vmcnt(4)
    v_bfe_u32 v67, v21, 0, 10
    v_lshl_add_u32 v67, v67, 2, s3
    ds_add_rtn_u32 v91, v67, v13
    v_bfe_u32 v68, v21, 10, 10
    v_lshl_add_u32 v68, v68, 2, s3
    ds_add_rtn_u32 v92, v68, v13
    v_bfe_u32 v69, v21, 20, 10
    v_lshl_add_u32 v69, v69, 2, s3
    ds_add_rtn_u32 v93, v69, v13
    v_mov_b32 v50, v23
    v_mad_u32_u16 v51, v50, 1, v137 op_sel:[1,0,0,0]
    v_mad_u32_u16 v21, v20, 1, v137 op_sel:[1,0,0,0]
    v_mad_u32_u16 v23, v22, 1, v137 op_sel:[1,0,0,0]
    s_waitcnt vmcnt(3)
    v_bfe_u32 v70, v25, 0, 10
    v_lshl_add_u32 v70, v70, 2, s3
    ds_add_rtn_u32 v94, v70, v13
    v_bfe_u32 v71, v25, 10, 10
    v_lshl_add_u32 v71, v71, 2, s3
    ds_add_rtn_u32 v95, v71, v13
    v_bfe_u32 v72, v25, 20, 10
    v_lshl_add_u32 v72, v72, 2, s3
    ds_add_rtn_u32 v96, v72, v13
    v_mov_b32 v52, v27
    v_mad_u32_u16 v53, v52, 1, v138 op_sel:[1,0,0,0]
    v_mad_u32_u16 v25, v24, 1, v138 op_sel:[1,0,0,0]
    v_mad_u32_u16 v27, v26, 1, v138 op_sel:[1,0,0,0]
    s_waitcnt vmcnt(2)
    v_bfe_u32 v73, v29, 0, 10
    v_lshl_add_u32 v73, v73, 2, s3
    ds_add_rtn_u32 v97, v73, v13
    v_bfe_u32 v74, v29, 10, 10
    v_lshl_add_u32 v74, v74, 2, s3
    ds_add_rtn_u32 v98, v74, v13
    v_bfe_u32 v75, v29, 20, 10
    v_lshl_add_u32 v75, v75, 2, s3
    ds_add_rtn_u32 v99, v75, v13
    v_mov_b32 v54, v31
    v_mad_u32_u16 v55, v54, 1, v139 op_sel:[1,0,0,0]
    v_mad_u32_u16 v29, v28, 1, v139 op_sel:[1,0,0,0]
    v_mad_u32_u16 v31, v30, 1, v139 op_sel:[1,0,0,0]
    s_waitcnt vmcnt(0)
    buffer_load_dwordx4 v244, s[4:7], s64 offen offset:0 lds
    buffer_load_dwordx4 v245, s[4:7], s64 offen offset:1024 lds
    buffer_load_dwordx4 v244, s[4:7], s64 offen offset:2048 lds
    buffer_load_dwordx4 v245, s[4:7], s64 offen offset:3072 lds
    s_add_u32 m0, m0, 4096
    s_add_u32 s64, s64, 4096
    buffer_load_dwordx4 v244, s[4:7], s64 offen offset:0 lds
    buffer_load_dwordx4 v245, s[4:7], s64 offen offset:1024 lds
    buffer_load_dwordx4 v244, s[4:7], s64 offen offset:2048 lds
    s_cmp_eq_u32 s60, 4
    s_cbranch_scc1 k2_rk_done
    v_bfe_u32 v76, v33, 0, 10
    v_lshl_add_u32 v76, v76, 2, s3
    ds_add_rtn_u32 v100, v76, v13
    v_bfe_u32 v77, v33, 10, 10
    v_lshl_add_u32 v77, v77, 2, s3
    ds_add_rtn_u32 v101, v77, v13
    v_bfe_u32 v78, v33, 20, 10
    v_lshl_add_u32 v78, v78, 2, s3
    ds_add_rtn_u32 v102, v78, v13
    v_mov_b32 v56, v35
    v_mad_u32_u16 v57, v56, 1, v140 op_sel:[1,0,0,0]
    v_mad_u32_u16 v33, v32, 1, v140 op_sel:[1,0,0,0]
    v_mad_u32_u16 v35, v34, 1, v140 op_sel:[1,0,0,0]
    s_cmp_eq_u32 s60, 5
    s_cbranch_scc1 k2_rk_done
    v_bfe_u32 v79, v37, 0, 10
    v_lshl_add_u32 v79, v79, 2, s3
    ds_add_rtn_u32 v103, v79, v13
    v_bfe_u32 v80, v37, 10, 10
    v_lshl_add_u32 v80, v80, 2, s3
    ds_add_rtn_u32 v104, v80, v13
    v_bfe_u32 v81, v37, 20, 10
    v_lshl_add_u32 v81, v81, 2, s3
    ds_add_rtn_u32 v105, v81, v13
    v_mov_b32 v58, v39
    v_mad_u32_u16 v59, v58, 1, v141 op_sel:[1,0,0,0]
    v_mad_u32_u16 v37, v36, 1, v141 op_sel:[1,0,0,0]
    v_mad_u32_u16 v39, v38, 1, v141 op_sel:[1,0,0,0]
    s_cmp_eq_u32 s60, 6
    s_cbranch_scc1 k2_rk_done
    v_bfe_u32 v82, v41, 0, 10
    v_lshl_add_u32 v82, v82, 2, s3
    ds_add_rtn_u32 v106, v82, v13
    v_bfe_u32 v83, v41, 10, 10
    v_lshl_add_u32 v83, v83, 2, s3
    ds_add_rtn_u32 v107, v83, v13
    v_bfe_u32 v84, v41, 20, 10
    v_lshl_add_u32 v84, v84, 2, s3
    ds_add_rtn_u32 v108, v84, v13
    v_mov_b32 v60, v43
    v_mad_u32_u16 v61, v60, 1, v142 op_sel:[1,0,0,0]
    v_mad_u32_u16 v41, v40, 1, v142 op_sel:[1,0,0,0]
    v_mad_u32_u16 v43, v42, 1, v142 op_sel:[1,0,0,0]
    s_cmp_eq_u32 s60, 7
    s_cbranch_scc1 k2_rk_done
    v_bfe_u32 v85, v45, 0, 10
    v_lshl_add_u32 v85, v85, 2, s3
    ds_add_rtn_u32 v109, v85, v13
    v_bfe_u32 v86, v45, 10, 10
    v_lshl_add_u32 v86, v86, 2, s3
    ds_add_rtn_u32 v110, v86, v13
    v_bfe_u32 v87, v45, 20, 10
    v_lshl_add_u32 v87, v87, 2, s3
    ds_add_rtn_u32 v111, v87, v13
    v_mov_b32 v62, v47
    v_mad_u32_u16 v63, v62, 1, v143 op_sel:[1,0,0,0]
    v_mad_u32_u16 v45, v44, 1, v143 op_sel:[1,0,0,0]
    v_mad_u32_u16 v47, v46, 1, v143 op_sel:[1,0,0,0]
k2_rk_done:
    v_mov_b32 v8, 1
    s_waitcnt lgkmcnt(0)
    s_barrier
    ds_read_b128 v[208:211], v6
    v_and_b32 v126, 31, v0
    s_movk_i32 s40, 240
    s_lshl_b32 s61, s28, 7
    s_sub_u32 s62, 896, s61
    s_bitcmp1_b32 s40, s28
    s_cselect_b32 s61, s61, s62
    s_add_u32 s62, s61, 156672
    s_sub_u32 s49, 157568, s61
    v_add_u32 v122, s30, v0
    v_cmp_gt_u32 vcc, s31, v0
    v_mov_b32 v123, 0xffff
    s_waitcnt lgkmcnt(0)
    v_add_u32 v212, v208, v209
    v_add3_u32 v5, v212, v210, v211
    v_cndmask_b32 v122, v123, v122, vcc
    s_mov_b64 exec, s[54:55]
    v_cmp_lt_u32 vcc, 62, v5
    s_mov_b64 exec, -1
    v_min_u32 v5, 62, v5
    v_lshlrev_b32 v7, 2, v5
    v_add_u32 v9, 163392, v7
    s_mov_b64 exec, s[54:55]
    ds_add_rtn_u32 v8, v9, v8
    s_mov_b64 exec, -1
    s_or_b64 s[52:53], s[52:53], vcc
    v_add_u32 v10, 1, v5
    v_lshrrev_b32 v11, 1, v10
    v_lshlrev_b32 v14, 2, v11
    v_lshlrev_b32 v15, 3, v5
    v_subrev_u32 v15, 8, v15
    v_min_u32 v15, 252, v15
    v_cmp_eq_u32 s[56:57], 0, v5
    v_add_u32 v213, v212, v210
    v_add_u32 v214, v210, v211
    v_add_u32 v215, v214, v209
    s_waitcnt lgkmcnt(0)
    s_barrier
    ds_read_b32 v9, v12
    v_cmp_eq_u32 s[58:59], 0, v8
    s_waitcnt lgkmcnt(0)
    v_cmp_ne_u32 s[46:47], 0, v9
    v_add_u32_dpp v9, v9, v9 row_shr:1 row_mask:0xf bank_mask:0xf
    v_lshrrev_b32 v124, 1, v5
    s_nop 0
    v_add_u32_dpp v9, v9, v9 row_shr:2 row_mask:0xf bank_mask:0xf
    v_lshrrev_b64 v[112:113], v10, s[46:47]
    v_ffbl_b32 v112, v112
    v_add_u32_dpp v9, v9, v9 row_shr:4 row_mask:0xf bank_mask:0xf
    v_ffbl_b32 v113, v113
    v_or_b32 v113, 32, v113
    v_add_u32_dpp v9, v9, v9 row_shr:8 row_mask:0xf bank_mask:0xf
    v_min_u32 v112, v112, v113
    v_add_lshl_u32 v112, v112, v10, 3
    v_add_u32_dpp v9, v9, v9 row_bcast:15 row_mask:0xa bank_mask:0xf
    v_subrev_u32 v112, 8, v112
    v_min_u32 v112, 252, v112
    v_add_u32_dpp v9, v9, v9 row_bcast:31 row_mask:0xc bank_mask:0xf
    v_sub_u32 v9, 196, v9
    ds_bpermute_b32 v114, v7, v9
    v_subrev_u32 v121, 62, v9
    v_subrev_u32 v123, 168, v9
    v_min_u32 v125, 30, v9
    v_med3_i32 v121, v121, 0, 14
    v_med3_i32 v123, v123, 0, 16
    v_add3_u32 v125, v125, v121, v123
    ds_bpermute_b32 v116, v15, v125
    ds_bpermute_b32 v117, v112, v125
    v_sub_u32 v9, v9, v125
    ds_bpermute_b32 v115, v14, v9
    v_mov_b32 v7, v126
    v_lshl_add_u32 v14, v7, 2, s62
    v_lshl_add_u32 v15, v7, 2, s49
    v_lshlrev_b32 v10, 7, v5
    s_waitcnt lgkmcnt(3)
    v_add_u32 v118, v114, v8
    v_add_u32 v119, 1, v118
    v_subrev_u32 v121, 62, v118
    v_subrev_u32 v123, 168, v118
    v_min_u32 v125, 30, v118
    v_med3_i32 v121, v121, 0, 14
    v_med3_i32 v123, v123, 0, 16
    v_add3_u32 v125, v125, v121, v123
    v_subrev_u32 v121, 62, v119
    v_subrev_u32 v123, 168, v119
    v_min_u32 v114, 30, v119
    v_med3_i32 v121, v121, 0, 14
    v_med3_i32 v123, v123, 0, 16
    v_add3_u32 v114, v114, v121, v123
    v_and_b32 v121, 1, v118
    v_cmp_ne_u32 s[46:47], v114, v125
    v_cmp_ne_u32 vcc, 0, v121
    v_sub_u32 v119, v118, v125
    s_waitcnt lgkmcnt(0)
    s_and_b64 vcc, vcc, s[58:59]
    v_cndmask_b32 v116, v116, 60, s[56:57]
    v_add_u32 v115, 1, v115
    v_lshrrev_b32 v115, 1, v115
    v_cndmask_b32 v116, v116, v117, vcc
    v_add_lshl_u32 v120, v125, v115, 1
    v_lshl_add_u32 v119, v116, 1, v119
    v_cndmask_b32 v120, v119, v120, s[46:47]
    v_cndmask_b32 v116, v5, v11, s[46:47]
    v_cndmask_b32 v114, 1, 0, s[46:47]
    v_lshrrev_b32 v121, 5, v120
    v_bfe_u32 v123, s40, v121, 1
    v_cmp_ne_u32 vcc, 0, v123
    v_sub_u32 v123, 7, v121
    v_min_u32 v121, v121, v123
    v_lshlrev_b32 v10, v114, v10
    v_sub_u32 v10, 148992, v10
    v_mov_b32 v123, 148992
    v_cndmask_b32 v10, v123, v10, vcc
    v_mul_i32_i24 v121, -12288, v121
    v_and_b32 v123, 1, v120
    v_and_b32 v115, 30, v120
    v_lshlrev_b32 v123, 7, v123
    v_lshl_add_u32 v123, v115, 2, v123
    v_add3_u32 v121, v121, v10, v123
    v_sub_u32 v114, 6, v114
    v_lshl_or_b32 v121, v121, v114, v114
    v_cndmask_b32 v209, v214, v208, vcc
    v_cndmask_b32 v210, v211, v212, vcc
    v_cndmask_b32 v208, v215, 0, vcc
    v_cndmask_b32 v211, 0, v213, vcc
    v_lshl_add_u32 v208, v208, 13, v121
    v_lshl_add_u32 v209, v209, 13, v121
    v_lshl_add_u32 v210, v210, 13, v121
    v_lshl_add_u32 v211, v211, 13, v121
    s_mov_b64 exec, s[54:55]
    ds_write_b128 v6, v[208:211]
    v_cndmask_b32 v123, 26, 22, vcc
    s_and_b64 s[58:59], vcc, s[46:47]
    v_cmp_gt_u32 s[56:57], v116, v123
    v_cndmask_b32 v123, v116, v124, s[58:59]
    v_cndmask_b32 v115, v124, v116, s[58:59]
    v_cndmask_b32 v114, 0, 1, s[46:47]
    v_lshl_or_b32 v123, v123, 8, v114
    v_lshl_or_b32 v123, v123, 16, v122
    v_lshlrev_b32 v120, 2, v120
    v_add_u32 v120, 156672, v120
    ds_write_b32 v120, v123
    v_lshl_or_b32 v115, v115, 8, 3
    v_lshl_or_b32 v115, v115, 16, v122
    s_or_b64 s[52:53], s[52:53], s[56:57]
    s_and_b64 exec, exec, s[46:47]
    ds_write_b32 v120, v115 offset:4
    s_mov_b64 exec, -1
    v_mov_b32 v11, 163648
    v_mov_b32 v13, s37
    s_mov_b64 exec, s[52:53]
    ds_or_b32 v11, v13
    s_mov_b64 exec, -1
    v_bfe_u32 v8, v0, 5, 1
    s_mul_i32 s46, s28, 12288
    s_sub_u32 s46, 144384, s46
    s_lshl_b32 s63, s30, 7
    s_sub_u32 s63, 69632, s63
    v_lshl_add_u32 v9, v8, 4, s63
    s_waitcnt lgkmcnt(0)
    s_barrier
    ds_read_b32 v11, v11
    ds_read_b32 v14, v14
    ds_read_b32 v15, v15
    ds_read_b32 v64, v64
    ds_read_b32 v65, v65
    ds_read_b32 v66, v66
    ds_read_b32 v67, v67
    ds_read_b32 v68, v68
    ds_read_b32 v69, v69
    ds_read_b32 v70, v70
    ds_read_b32 v71, v71
    s_movk_i32 s63, 128
    s_waitcnt lgkmcnt(8)
    v_readfirstlane_b32 s47, v11
    v_readlane_b32 s38, v14, 0
    v_readlane_b32 s61, v14, 1
    v_readlane_b32 s39, v15, 0
    s_cmp_lg_u32 s47, 0
    s_cbranch_scc1 k2_slow_w
    ds_read_b32 v72, v72
    s_max_u32 s38, s38, s61
    s_lshr_b32 s38, s38, 24
    s_max_u32 s38, s38, 1
    s_sub_u32 s47, 22, s38
    s_mul_i32 s57, s47, 128
    s_lshr_b32 s57, s57, 8
    s_mul_i32 s57, s57, 2
    s_sub_u32 s56, s47, s57
    s_mul_i32 s59, s56, 5248
    s_lshl_b32 s38, s38, 24
    s_waitcnt lgkmcnt(8)
    v_lshl_add_u32 v88, v88, 13, v64
    v_lshrrev_b32 v88, v88, v88
    ds_write_b64 v88, v[16:17] offset:1024
    ds_read_b32 v73, v73
    s_and_b32 s39, s39, 0xff000000
    s_max_u32 s39, s39, 0x01000000
    s_lshl_b32 s57, s57, 8
    s_add_u32 s57, s57, s46
    s_lshl_b32 s58, s56, 8
    s_sub_u32 s61, 5248, s59
    v_mad_u32_u16 v251, v14, s63, v9
    v_mad_u32_u16 v9, v15, s63, v9
    v_add_u32 v1, s57, v242
    v_add_u32 v0, s57, v243
    s_waitcnt lgkmcnt(9)
    v_lshl_add_u32 v89, v89, 13, v65
    v_lshrrev_b32 v89, v89, v89
    ds_write_b64 v89, v[18:19] offset:1024
    ds_read_b32 v74, v74
    v_add_u32 v253, s58, v1
    v_add_u32 v252, s58, v0
    v_mov_b32 v12, v240
    v_mov_b32 v13, v241
    v_accvgpr_write_b32 a236, v15
    v_lshrrev_b32 v208, 4, v9
    v_and_b32 v208, 0x70, v208
    v_xor_b32 v208, v208, v9
    v_xor_b32 v209, 32, v208
    v_xor_b32 v210, 64, v208
    s_waitcnt lgkmcnt(10)
    v_lshl_add_u32 v90, v90, 13, v66
    v_lshrrev_b32 v90, v90, v90
    ds_write_b64 v90, v[48:49] offset:1024
    ds_read_b32 v75, v75
    v_xor_b32 v211, 96, v208
    v_lshrrev_b32 v212, 4, v251
    v_and_b32 v212, 0x70, v212
    v_xor_b32 v212, v212, v251
    v_xor_b32 v213, 32, v212
    v_xor_b32 v214, 64, v212
    v_xor_b32 v215, 96, v212
    s_waitcnt lgkmcnt(11)
    v_lshl_add_u32 v91, v91, 13, v67
    v_lshrrev_b32 v91, v91, v91
    ds_write_b64 v91, v[20:21] offset:1024
    s_cmp_eq_u32 s60, 4
    s_cbranch_scc1 k2_sc_t4
    ds_read_b32 v76, v76
    s_waitcnt lgkmcnt(12)
    v_lshl_add_u32 v92, v92, 13, v68
    v_lshrrev_b32 v92, v92, v92
    ds_write_b64 v92, v[22:23] offset:1024
    ds_read_b32 v77, v77
    s_waitcnt lgkmcnt(13)
    v_lshl_add_u32 v93, v93, 13, v69
    v_lshrrev_b32 v93, v93, v93
    ds_write_b64 v93, v[50:51] offset:1024
    ds_read_b32 v78, v78
    s_waitcnt lgkmcnt(14)
    v_lshl_add_u32 v94, v94, 13, v70
    v_lshrrev_b32 v94, v94, v94
    ds_write_b64 v94, v[24:25] offset:1024
    s_cmp_eq_u32 s60, 5
    s_cbranch_scc1 k2_sc_t5
    ds_read_b32 v79, v79
    s_waitcnt lgkmcnt(15)
    v_lshl_add_u32 v95, v95, 13, v71
    v_lshrrev_b32 v95, v95, v95
    ds_write_b64 v95, v[26:27] offset:1024
    ds_read_b32 v80, v80
    s_waitcnt lgkmcnt(15)
    v_lshl_add_u32 v96, v96, 13, v72
    v_lshrrev_b32 v96, v96, v96
    ds_write_b64 v96, v[52:53] offset:1024
    ds_read_b32 v81, v81
    s_waitcnt lgkmcnt(15)
    v_lshl_add_u32 v97, v97, 13, v73
    v_lshrrev_b32 v97, v97, v97
    ds_write_b64 v97, v[28:29] offset:1024
    s_cmp_eq_u32 s60, 6
    s_cbranch_scc1 k2_sc_t6
    ds_read_b32 v82, v82
    s_waitcnt lgkmcnt(15)
    v_lshl_add_u32 v98, v98, 13, v74
    v_lshrrev_b32 v98, v98, v98
    ds_write_b64 v98, v[30:31] offset:1024
    ds_read_b32 v83, v83
    s_waitcnt lgkmcnt(15)
    v_lshl_add_u32 v99, v99, 13, v75
    v_lshrrev_b32 v99, v99, v99
    ds_write_b64 v99, v[54:55] offset:1024
    ds_read_b32 v84, v84
    s_waitcnt lgkmcnt(15)
    v_lshl_add_u32 v100, v100, 13, v76
    v_lshrrev_b32 v100, v100, v100
    ds_write_b64 v100, v[32:33] offset:1024
    s_cmp_eq_u32 s60, 7
    s_cbranch_scc1 k2_sc_t7
    ds_read_b32 v85, v85
    s_waitcnt lgkmcnt(15)
    v_lshl_add_u32 v101, v101, 13, v77
    v_lshrrev_b32 v101, v101, v101
    ds_write_b64 v101, v[34:35] offset:1024
    ds_read_b32 v86, v86
    s_waitcnt lgkmcnt(15)
    v_lshl_add_u32 v102, v102, 13, v78
    v_lshrrev_b32 v102, v102, v102
    ds_write_b64 v102, v[56:57] offset:1024
    ds_read_b32 v87, v87
    s_waitcnt lgkmcnt(15)
    v_lshl_add_u32 v103, v103, 13, v79
    v_lshrrev_b32 v103, v103, v103
    ds_write_b64 v103, v[36:37] offset:1024
    s_waitcnt lgkmcnt(1)
    v_lshl_add_u32 v104, v104, 13, v80
    v_lshrrev_b32 v104, v104, v104
    ds_write_b64 v104, v[38:39] offset:1024
    v_lshl_add_u32 v105, v105, 13, v81
    v_lshrrev_b32 v105, v105, v105
    ds_write_b64 v105, v[58:59] offset:1024
    v_lshl_add_u32 v106, v106, 13, v82
    v_lshrrev_b32 v106, v106, v106
    ds_write_b64 v106, v[40:41] offset:1024
    v_lshl_add_u32 v107, v107, 13, v83
    v_lshrrev_b32 v107, v107, v107
    ds_write_b64 v107, v[42:43] offset:1024
    v_lshl_add_u32 v108, v108, 13, v84
    v_lshrrev_b32 v108, v108, v108
    ds_write_b64 v108, v[60:61] offset:1024
    v_lshl_add_u32 v109, v109, 13, v85
    v_lshrrev_b32 v109, v109, v109
    ds_write_b64 v109, v[44:45] offset:1024
    v_lshl_add_u32 v110, v110, 13, v86
    v_lshrrev_b32 v110, v110, v110
    ds_write_b64 v110, v[46:47] offset:1024
    v_lshl_add_u32 v111, v111, 13, v87
    v_lshrrev_b32 v111, v111, v111
    ds_write_b64 v111, v[62:63] offset:1024
    s_branch k2_sc_done
k2_sc_t7:
    s_waitcnt lgkmcnt(1)
    v_lshl_add_u32 v101, v101, 13, v77
    v_lshrrev_b32 v101, v101, v101
    ds_write_b64 v101, v[34:35] offset:1024
    v_lshl_add_u32 v102, v102, 13, v78
    v_lshrrev_b32 v102, v102, v102
    ds_write_b64 v102, v[56:57] offset:1024
    v_lshl_add_u32 v103, v103, 13, v79
    v_lshrrev_b32 v103, v103, v103
    ds_write_b64 v103, v[36:37] offset:1024
    v_lshl_add_u32 v104, v104, 13, v80
    v_lshrrev_b32 v104, v104, v104
    ds_write_b64 v104, v[38:39] offset:1024
    v_lshl_add_u32 v105, v105, 13, v81
    v_lshrrev_b32 v105, v105, v105
    ds_write_b64 v105, v[58:59] offset:1024
    v_lshl_add_u32 v106, v106, 13, v82
    v_lshrrev_b32 v106, v106, v106
    ds_write_b64 v106, v[40:41] offset:1024
    v_lshl_add_u32 v107, v107, 13, v83
    v_lshrrev_b32 v107, v107, v107
    ds_write_b64 v107, v[42:43] offset:1024
    v_lshl_add_u32 v108, v108, 13, v84
    v_lshrrev_b32 v108, v108, v108
    ds_write_b64 v108, v[60:61] offset:1024
    s_branch k2_sc_done
k2_sc_t6:
    s_waitcnt lgkmcnt(1)
    v_lshl_add_u32 v98, v98, 13, v74
    v_lshrrev_b32 v98, v98, v98
    ds_write_b64 v98, v[30:31] offset:1024
    v_lshl_add_u32 v99, v99, 13, v75
    v_lshrrev_b32 v99, v99, v99
    ds_write_b64 v99, v[54:55] offset:1024
    v_lshl_add_u32 v100, v100, 13, v76
    v_lshrrev_b32 v100, v100, v100
    ds_write_b64 v100, v[32:33] offset:1024
    v_lshl_add_u32 v101, v101, 13, v77
    v_lshrrev_b32 v101, v101, v101
    ds_write_b64 v101, v[34:35] offset:1024
    v_lshl_add_u32 v102, v102, 13, v78
    v_lshrrev_b32 v102, v102, v102
    ds_write_b64 v102, v[56:57] offset:1024
    v_lshl_add_u32 v103, v103, 13, v79
    v_lshrrev_b32 v103, v103, v103
    ds_write_b64 v103, v[36:37] offset:1024
    v_lshl_add_u32 v104, v104, 13, v80
    v_lshrrev_b32 v104, v104, v104
    ds_write_b64 v104, v[38:39] offset:1024
    v_lshl_add_u32 v105, v105, 13, v81
    v_lshrrev_b32 v105, v105, v105
    ds_write_b64 v105, v[58:59] offset:1024
    s_branch k2_sc_done
k2_sc_t5:
    s_waitcnt lgkmcnt(1)
    v_lshl_add_u32 v95, v95, 13, v71
    v_lshrrev_b32 v95, v95, v95
    ds_write_b64 v95, v[26:27] offset:1024
    v_lshl_add_u32 v96, v96, 13, v72
    v_lshrrev_b32 v96, v96, v96
    ds_write_b64 v96, v[52:53] offset:1024
    v_lshl_add_u32 v97, v97, 13, v73
    v_lshrrev_b32 v97, v97, v97
    ds_write_b64 v97, v[28:29] offset:1024
    v_lshl_add_u32 v98, v98, 13, v74
    v_lshrrev_b32 v98, v98, v98
    ds_write_b64 v98, v[30:31] offset:1024
    v_lshl_add_u32 v99, v99, 13, v75
    v_lshrrev_b32 v99, v99, v99
    ds_write_b64 v99, v[54:55] offset:1024
    v_lshl_add_u32 v100, v100, 13, v76
    v_lshrrev_b32 v100, v100, v100
    ds_write_b64 v100, v[32:33] offset:1024
    v_lshl_add_u32 v101, v101, 13, v77
    v_lshrrev_b32 v101, v101, v101
    ds_write_b64 v101, v[34:35] offset:1024
    v_lshl_add_u32 v102, v102, 13, v78
    v_lshrrev_b32 v102, v102, v102
    ds_write_b64 v102, v[56:57] offset:1024
    s_branch k2_sc_done
k2_sc_t4:
    s_waitcnt lgkmcnt(1)
    v_lshl_add_u32 v92, v92, 13, v68
    v_lshrrev_b32 v92, v92, v92
    ds_write_b64 v92, v[22:23] offset:1024
    v_lshl_add_u32 v93, v93, 13, v69
    v_lshrrev_b32 v93, v93, v93
    ds_write_b64 v93, v[50:51] offset:1024
    v_lshl_add_u32 v94, v94, 13, v70
    v_lshrrev_b32 v94, v94, v94
    ds_write_b64 v94, v[24:25] offset:1024
    v_lshl_add_u32 v95, v95, 13, v71
    v_lshrrev_b32 v95, v95, v95
    ds_write_b64 v95, v[26:27] offset:1024
    v_lshl_add_u32 v96, v96, 13, v72
    v_lshrrev_b32 v96, v96, v96
    ds_write_b64 v96, v[52:53] offset:1024
    v_lshl_add_u32 v97, v97, 13, v73
    v_lshrrev_b32 v97, v97, v97
    ds_write_b64 v97, v[28:29] offset:1024
    v_lshl_add_u32 v98, v98, 13, v74
    v_lshrrev_b32 v98, v98, v98
    ds_write_b64 v98, v[30:31] offset:1024
    v_lshl_add_u32 v99, v99, 13, v75
    v_lshrrev_b32 v99, v99, v99
    ds_write_b64 v99, v[54:55] offset:1024
k2_sc_done:
    s_add_u32 s59, s59, s36
    s_add_u32 s61, s61, s36
    s_mov_b32 m0, s59
    s_waitcnt vmcnt(0) lgkmcnt(0)
    s_barrier
    ds_read_u16 v218, v253 offset:0
    ds_read_u16 v220, v253 offset:32
    ds_read_u16 v222, v253 offset:64
    ds_read_u16 v224, v253 offset:96
    ds_read_b32 v226, v252 offset:4
    ds_read_u16 v228, v253 offset:256
    ds_read_u16 v230, v253 offset:288
    ds_read_u16 v232, v253 offset:320
    ds_read_u16 v234, v253 offset:352
    ds_read_b32 v236, v252 offset:260
    ds_read_b128 a[240:243], v208
    ds_read_b128 a[244:247], v209
    ds_read_b128 a[248:251], v210
    ds_read_b128 a[252:255], v211
    s_waitcnt lgkmcnt(9)
    buffer_load_dwordx4 v[218:219], s[8:11], s33 idxen offen offset:0 lds
    buffer_load_dwordx4 v[220:221], s[8:11], s34 idxen offen offset:1056 lds
    buffer_load_dwordx4 v[222:223], s[8:11], s35 idxen offen offset:2112 lds
    buffer_load_dwordx4 v[224:225], s[8:11], 0 idxen offen offset:3168 lds
    s_add_u32 m0, m0, 4224
    s_nop 0
    buffer_load_dwordx4 v[226:227], s[12:15], 0 idxen offen lds
    ds_read_b128 a[216:219], v212
    ds_read_b128 a[220:223], v213
    ds_read_b128 a[224:227], v214
    ds_read_b128 a[228:231], v215
    ds_read_u16 v2, v253 offset:512
    ds_read_u16 v4, v253 offset:544
    ds_read_u16 v6, v253 offset:576
    ds_read_u16 v8, v253 offset:608
    ds_read_b32 v10, v252 offset:516
    ds_bpermute_b32 v208, v246, v14 offset:0
    ds_bpermute_b32 v209, v246, v14 offset:32
    ds_bpermute_b32 v210, v246, v14 offset:64
    ds_bpermute_b32 v211, v246, v14 offset:96
    ds_bpermute_b32 v212, v246, v15 offset:0
    ds_bpermute_b32 v213, v246, v15 offset:32
    ds_bpermute_b32 v214, v246, v15 offset:64
    ds_bpermute_b32 v215, v246, v15 offset:96
    s_waitcnt lgkmcnt(15)
    v_mfma_f32_32x32x16_bf16 v[16:31], a[80:83], a[240:243], v[144:159]
    s_mov_b32 m0, s61
    s_nop 0
    buffer_load_dwordx4 v[228:229], s[8:11], s33 idxen offen offset:0 lds
    v_mfma_f32_32x32x16_bf16 v[16:31], a[84:87], a[244:247], v[16:31]
    buffer_load_dwordx4 v[230:231], s[8:11], s34 idxen offen offset:1056 lds
    buffer_load_dwordx4 v[232:233], s[8:11], s35 idxen offen offset:2112 lds
    v_mfma_f32_32x32x16_bf16 v[16:31], a[88:91], a[248:251], v[16:31]
    buffer_load_dwordx4 v[234:235], s[8:11], 0 idxen offen offset:3168 lds
    s_add_u32 m0, m0, 4224
    s_nop 0
    buffer_load_dwordx4 v[236:237], s[12:15], 0 idxen offen lds
    v_mfma_f32_32x32x16_bf16 v[16:31], a[92:95], a[252:255], v[16:31]
    v_mov_b32 v3, v255
    v_mov_b32 v5, v255
    v_mov_b32 v7, v255
    v_mfma_f32_32x32x16_bf16 v[32:47], a[96:99], a[240:243], v[160:175]
    v_mov_b32 v9, v255
    v_mov_b32 v11, v254
    s_sub_u32 s59, s59, s36
    v_mfma_f32_32x32x16_bf16 v[32:47], a[100:103], a[244:247], v[32:47]
    v_add_u32 v249, s59, v12
    v_add_u32 v248, s59, v13
    v_mov_b32 v246, v15
    s_nop 1
    v_mfma_f32_32x32x16_bf16 v[32:47], a[104:107], a[248:251], v[32:47]
    v_min_u32_dpp v246, v246, v246 row_shr:1 row_mask:0xf bank_mask:0xf
    s_nop 1
    v_min_u32_dpp v246, v246, v246 row_shr:2 row_mask:0xf bank_mask:0xf
    s_nop 1
    v_min_u32_dpp v246, v246, v246 row_shr:4 row_mask:0xf bank_mask:0xf
    s_nop 1
    v_mfma_f32_32x32x16_bf16 v[32:47], a[108:111], a[252:255], v[32:47]
    v_min_u32_dpp v246, v246, v246 row_shr:8 row_mask:0xf bank_mask:0xf
    s_nop 1
    v_min_u32_dpp v246, v246, v246 row_bcast:15 row_mask:0xa bank_mask:0xf
    s_nop 1
    v_readlane_b32 s49, v246, 31
    s_waitcnt lgkmcnt(0)
    s_barrier
    v_mfma_f32_32x32x16_bf16 v[48:63], a[112:115], a[240:243], v[176:191]
    ds_write_b128 v247, v[16:19] offset:0
    v_mfma_f32_32x32x16_bf16 v[48:63], a[116:119], a[244:247], v[48:63]
    ds_write_b128 v247, v[20:23] offset:1024
    v_mov_b32 v16, 0
    v_mov_b32 v17, 0
    v_mov_b32 v18, 0
    v_mov_b32 v19, 0
    v_mfma_f32_32x32x16_bf16 v[48:63], a[120:123], a[248:251], v[48:63]
    v_mov_b32 v80, 1.0
    v_mov_b32 v81, 1.0
    v_mov_b32 v82, 1.0
    v_mov_b32 v83, 1.0
    v_mov_b32 v84, 1.0
    v_mov_b32 v85, 1.0
    v_mov_b32 v86, 1.0
    v_mov_b32 v87, 1.0
    v_mfma_f32_32x32x16_bf16 v[48:63], a[124:127], a[252:255], v[48:63]
    ds_write_b128 v247, v[24:27] offset:2048
    v_mov_b32 v20, 0
    v_mov_b32 v21, 0
    v_mov_b32 v22, 0
    v_mov_b32 v23, 0
    v_mfma_f32_32x32x16_bf16 v[64:79], a[128:131], a[240:243], v[192:207]
    ds_write_b128 v247, v[28:31] offset:3072
    v_mov_b32 v24, 0
    v_mov_b32 v25, 0
    v_mov_b32 v26, 0
    v_mov_b32 v27, 0
    v_mfma_f32_32x32x16_bf16 v[64:79], a[132:135], a[244:247], v[64:79]
    v_mov_b32 v88, 1.0
    v_mov_b32 v89, 1.0
    v_mov_b32 v90, 1.0
    v_mov_b32 v91, 1.0
    v_mov_b32 v92, 1.0
    v_mov_b32 v93, 1.0
    v_mov_b32 v94, 1.0
    v_mov_b32 v95, 1.0
    v_mfma_f32_32x32x16_bf16 v[64:79], a[136:139], a[248:251], v[64:79]
    ds_write_b128 v247, v[32:35] offset:4096
    v_mov_b32 v28, 0
    v_mov_b32 v29, 0
    v_mov_b32 v30, 0
    v_mov_b32 v31, 0
    v_mfma_f32_32x32x16_bf16 v[64:79], a[140:143], a[252:255], v[64:79]
    ds_write_b128 v247, v[36:39] offset:5120
    v_mov_b32 v32, 0
    v_mov_b32 v33, 0
    v_mov_b32 v34, 0
    v_mov_b32 v35, 0
    v_mfma_f32_32x32x16_bf16 v[144:159], a[80:83], a[216:219], v[144:159]
    v_mov_b32 v96, 1.0
    v_mov_b32 v97, 1.0
    v_mov_b32 v98, 1.0
    v_mov_b32 v99, 1.0
    v_mov_b32 v100, 1.0
    v_mov_b32 v101, 1.0
    v_mov_b32 v102, 1.0
    v_mov_b32 v103, 1.0
    v_mfma_f32_32x32x16_bf16 v[144:159], a[84:87], a[220:223], v[144:159]
    v_accvgpr_write_b32 a241, v238
    ds_write_b128 v247, v[40:43] offset:6144
    v_mov_b32 v36, 0
    v_mov_b32 v37, 0
    v_mov_b32 v38, 0
    v_mov_b32 v39, 0
    v_mfma_f32_32x32x16_bf16 v[144:159], a[88:91], a[224:227], v[144:159]
    v_and_b32 v244, 0x20000, v208
    v_mad_u32_u16 v208, v208, s63, v239
    v_lshl_or_b32 v208, v244, 13, v208
    v_accvgpr_write_b32 a242, v208
    ds_write_b128 v247, v[44:47] offset:7168
    v_mov_b32 v40, 0
    v_mov_b32 v41, 0
    v_mov_b32 v42, 0
    v_mov_b32 v43, 0
    v_mfma_f32_32x32x16_bf16 v[144:159], a[92:95], a[228:231], v[144:159]
    v_mov_b32 v104, 1.0
    v_mov_b32 v105, 1.0
    v_mov_b32 v106, 1.0
    v_mov_b32 v107, 1.0
    v_mov_b32 v108, 1.0
    v_mov_b32 v109, 1.0
    v_mov_b32 v110, 1.0
    v_mov_b32 v111, 1.0
    v_and_b32 v244, 0x20000, v209
    v_mad_u32_u16 v209, v209, s63, v239
    v_lshl_or_b32 v209, v244, 13, v209
    v_accvgpr_write_b32 a243, v209
    v_mfma_f32_32x32x16_bf16 v[160:175], a[96:99], a[216:219], v[160:175]
    v_and_b32 v244, 0x20000, v210
    v_mad_u32_u16 v210, v210, s63, v239
    v_lshl_or_b32 v210, v244, 13, v210
    v_accvgpr_write_b32 a244, v210
    ds_write_b128 v247, v[48:51] offset:8192
    v_mov_b32 v44, 0
    v_mov_b32 v45, 0
    v_mov_b32 v46, 0
    v_mov_b32 v47, 0
    v_mfma_f32_32x32x16_bf16 v[160:175], a[100:103], a[220:223], v[160:175]
    v_and_b32 v244, 0x20000, v211
    v_mad_u32_u16 v211, v211, s63, v239
    v_lshl_or_b32 v211, v244, 13, v211
    v_accvgpr_write_b32 a245, v211
    ds_write_b128 v247, v[52:55] offset:9216
    v_mov_b32 v48, 0
    v_mov_b32 v49, 0
    v_mov_b32 v50, 0
    v_mov_b32 v51, 0
    v_mfma_f32_32x32x16_bf16 v[160:175], a[104:107], a[224:227], v[160:175]
    v_mov_b32 v112, 1.0
    v_mov_b32 v113, 1.0
    v_mov_b32 v114, 1.0
    v_mov_b32 v115, 1.0
    v_mov_b32 v116, 1.0
    v_mov_b32 v117, 1.0
    v_mov_b32 v118, 1.0
    v_mov_b32 v119, 1.0
    v_and_b32 v244, 0x20000, v212
    v_mad_u32_u16 v212, v212, s63, v239
    v_lshl_or_b32 v212, v244, 13, v212
    v_accvgpr_write_b32 a246, v212
    v_mfma_f32_32x32x16_bf16 v[160:175], a[108:111], a[228:231], v[160:175]
    v_and_b32 v244, 0x20000, v213
    v_mad_u32_u16 v213, v213, s63, v239
    v_lshl_or_b32 v213, v244, 13, v213
    v_accvgpr_write_b32 a247, v213
    ds_write_b128 v247, v[56:59] offset:10240
    v_mov_b32 v52, 0
    v_mov_b32 v53, 0
    v_mov_b32 v54, 0
    v_mov_b32 v55, 0
    v_mfma_f32_32x32x16_bf16 v[176:191], a[112:115], a[216:219], v[176:191]
    v_and_b32 v244, 0x20000, v214
    v_mad_u32_u16 v214, v214, s63, v239
    v_lshl_or_b32 v214, v244, 13, v214
    v_accvgpr_write_b32 a248, v214
    ds_write_b128 v247, v[60:63] offset:11264
    v_mov_b32 v56, 0
    v_mov_b32 v57, 0
    v_mov_b32 v58, 0
    v_mov_b32 v59, 0
    v_mfma_f32_32x32x16_bf16 v[176:191], a[116:119], a[220:223], v[176:191]
    v_mov_b32 v120, 1.0
    v_mov_b32 v121, 1.0
    v_mov_b32 v122, 1.0
    v_mov_b32 v123, 1.0
    v_mov_b32 v124, 1.0
    v_mov_b32 v125, 1.0
    v_mov_b32 v126, 1.0
    v_mov_b32 v127, 1.0
    v_and_b32 v244, 0x20000, v215
    v_mad_u32_u16 v215, v215, s63, v239
    v_lshl_or_b32 v215, v244, 13, v215
    v_accvgpr_write_b32 a249, v215
    v_mfma_f32_32x32x16_bf16 v[176:191], a[120:123], a[224:227], v[176:191]
    ds_write_b128 v247, v[64:67] offset:12288
    v_mov_b32 v60, 0
    v_mov_b32 v61, 0
    v_mov_b32 v62, 0
    v_mov_b32 v63, 0
    v_mfma_f32_32x32x16_bf16 v[176:191], a[124:127], a[228:231], v[176:191]
    ds_write_b128 v247, v[68:71] offset:13312
    v_mov_b32 v64, 0
    v_mov_b32 v65, 0
    v_mov_b32 v66, 0
    v_mov_b32 v67, 0
    v_mfma_f32_32x32x16_bf16 v[192:207], a[128:131], a[216:219], v[192:207]
    v_mov_b32 v128, 1.0
    v_mov_b32 v129, 1.0
    v_mov_b32 v130, 1.0
    v_mov_b32 v131, 1.0
    v_mov_b32 v132, 1.0
    v_mov_b32 v133, 1.0
    v_mov_b32 v134, 1.0
    v_mov_b32 v135, 1.0
    v_mfma_f32_32x32x16_bf16 v[192:207], a[132:135], a[220:223], v[192:207]
    ds_write_b128 v247, v[72:75] offset:14336
    v_mov_b32 v68, 0
    v_mov_b32 v69, 0
    v_mov_b32 v70, 0
    v_mov_b32 v71, 0
    v_mfma_f32_32x32x16_bf16 v[192:207], a[136:139], a[224:227], v[192:207]
    ds_write_b128 v247, v[76:79] offset:15360
    v_mov_b32 v72, 0
    v_mov_b32 v73, 0
    v_mov_b32 v74, 0
    v_mov_b32 v75, 0
    v_mfma_f32_32x32x16_bf16 v[192:207], a[140:143], a[228:231], v[192:207]
    v_mov_b32 v136, 1.0
    v_mov_b32 v137, 1.0
    v_mov_b32 v138, 1.0
    v_mov_b32 v139, 1.0
    v_mov_b32 v140, 1.0
    v_mov_b32 v141, 1.0
    v_mov_b32 v142, 1.0
    v_mov_b32 v143, 1.0
    s_and_b32 s49, s49, 0xff000000
    s_sub_u32 s47, s39, 0x01000000
    s_min_u32 s49, s49, s47
    s_sub_u32 s51, s39, 117440512
    s_sub_u32 s47, s49, 0x01000000
    s_min_i32 s51, s51, s47
    s_sub_u32 s50, s39, 184549376
    s_sub_u32 s47, s51, 0x01000000
    s_min_i32 s50, s50, s47
    v_mov_b32 v76, 0
    v_mov_b32 v77, 0
    v_mov_b32 v78, 0
    v_mov_b32 v79, 0
    s_waitcnt vmcnt(5)
    ds_read_b128 a[216:219], v249 offset:0
    ds_read_b128 a[220:223], v249 offset:32
    ds_read_b128 a[224:227], v249 offset:64
    ds_read_b128 a[228:231], v249 offset:96
    ds_read_b128 a[232:235], v248 offset:4224
    s_waitcnt lgkmcnt(4)
    v_mfma_f32_32x32x16_bf16 v[208:223], a[0:3], a[216:219], v[144:159]
    s_waitcnt lgkmcnt(3)
    v_mfma_f32_32x32x16_bf16 v[208:223], a[4:7], a[220:223], v[208:223]
    s_waitcnt lgkmcnt(2)
    v_mfma_f32_32x32x16_bf16 v[208:223], a[8:11], a[224:227], v[208:223]
    s_waitcnt lgkmcnt(1)
    v_mfma_f32_32x32x16_bf16 v[208:223], a[12:15], a[228:231], v[208:223]
    s_waitcnt lgkmcnt(0)
    v_mfma_f32_32x32x16_bf16 v[208:223], a[16:19], a[232:235], v[208:223]
    s_add_u32 m0, s59, s36
    s_add_u32 s37, s38, s39
    s_lshr_b32 s37, s37, 24
    s_sub_u32 s37, 28, s37
    s_cselect_b32 s37, 0, s37
    s_min_u32 s37, s37, 7
    s_lshl_b32 s37, s37, 2
    s_lshr_b32 s37, 4294599441, s37
    s_and_b32 s37, s37, 15
    s_lshl_b32 s47, s37, 24
    s_sub_u32 s37, s38, s47
    s_cselect_b32 s37, 0, s37
    s_cmp_eq_u32 s56, 1
    s_cbranch_scc1 k2_lp1
.p2align 3
k2_lp0:
    v_mfma_f32_32x32x16_bf16 v[224:239], a[20:23], a[216:219], v[160:175]
    s_mov_b64 exec, -1
    v_exp_f32 v240, v208
    v_exp_f32 v241, v209
    v_exp_f32 v242, v210
    v_mfma_f32_32x32x16_bf16 v[224:239], a[24:27], a[220:223], v[224:239]
    v_cmp_le_u32 s[42:43], s38, v14
    v_exp_f32 v243, v211
    v_exp_f32 v244, v212
    v_exp_f32 v245, v213
    v_mfma_f32_32x32x16_bf16 v[224:239], a[28:31], a[224:227], v[224:239]
    v_exp_f32 v246, v214
    v_exp_f32 v247, v215
    v_exp_f32 v248, v216
    v_mfma_f32_32x32x16_bf16 v[224:239], a[32:35], a[228:231], v[224:239]
    v_exp_f32 v249, v217
    v_exp_f32 v250, v218
    v_exp_f32 v251, v219
    v_mfma_f32_32x32x16_bf16 v[224:239], a[36:39], a[232:235], v[224:239]
    s_mov_b64 exec, s[42:43]
    v_exp_f32 v252, v220
    v_exp_f32 v253, v221
    v_exp_f32 v254, v222
    v_exp_f32 v255, v223
    v_pk_fma_f32 v[16:17], v[16:17], v[240:241], v[16:17]
    v_pk_fma_f32 v[18:19], v[18:19], v[242:243], v[18:19]
    v_pk_fma_f32 v[20:21], v[20:21], v[244:245], v[20:21]
    v_pk_fma_f32 v[22:23], v[22:23], v[246:247], v[22:23]
    v_pk_fma_f32 v[24:25], v[24:25], v[248:249], v[24:25]
    v_pk_fma_f32 v[26:27], v[26:27], v[250:251], v[26:27]
    v_pk_fma_f32 v[28:29], v[28:29], v[252:253], v[28:29]
    v_pk_fma_f32 v[30:31], v[30:31], v[254:255], v[30:31]
    v_pk_fma_f32 v[16:17], v[208:209], v[80:81], v[16:17]
    v_pk_fma_f32 v[18:19], v[210:211], v[82:83], v[18:19]
    v_pk_fma_f32 v[20:21], v[212:213], v[84:85], v[20:21]
    v_pk_fma_f32 v[22:23], v[214:215], v[86:87], v[22:23]
    v_pk_fma_f32 v[24:25], v[216:217], v[88:89], v[24:25]
    v_pk_fma_f32 v[26:27], v[218:219], v[90:91], v[26:27]
    v_pk_fma_f32 v[28:29], v[220:221], v[92:93], v[28:29]
    v_pk_fma_f32 v[30:31], v[222:223], v[94:95], v[30:31]
    v_pk_fma_f32 v[80:81], v[80:81], v[240:241], v[80:81]
    v_pk_fma_f32 v[82:83], v[82:83], v[242:243], v[82:83]
    v_pk_fma_f32 v[84:85], v[84:85], v[244:245], v[84:85]
    v_pk_fma_f32 v[86:87], v[86:87], v[246:247], v[86:87]
    v_pk_fma_f32 v[88:89], v[88:89], v[248:249], v[88:89]
    v_pk_fma_f32 v[90:91], v[90:91], v[250:251], v[90:91]
    v_pk_fma_f32 v[92:93], v[92:93], v[252:253], v[92:93]
    v_pk_fma_f32 v[94:95], v[94:95], v[254:255], v[94:95]
    v_mfma_f32_32x32x16_bf16 v[208:223], a[40:43], a[216:219], v[176:191]
    s_waitcnt vmcnt(0)
    v_exp_f32 v240, v224
    v_exp_f32 v241, v225
    v_exp_f32 v242, v226
    v_mfma_f32_32x32x16_bf16 v[208:223], a[44:47], a[220:223], v[208:223]
    s_sub_u32 s38, s38, 0x01000000
    v_exp_f32 v243, v227
    v_exp_f32 v244, v228
    v_exp_f32 v245, v229
    v_mfma_f32_32x32x16_bf16 v[208:223], a[48:51], a[224:227], v[208:223]
    s_cmp_gt_u32 s38, s37
    v_exp_f32 v246, v230
    v_exp_f32 v247, v231
    v_exp_f32 v248, v232
    v_mfma_f32_32x32x16_bf16 v[208:223], a[52:55], a[228:231], v[208:223]
    v_exp_f32 v249, v233
    v_exp_f32 v250, v234
    v_exp_f32 v251, v235
    v_mfma_f32_32x32x16_bf16 v[208:223], a[56:59], a[232:235], v[208:223]
    v_exp_f32 v252, v236
    v_exp_f32 v253, v237
    v_exp_f32 v254, v238
    v_exp_f32 v255, v239
    v_pk_fma_f32 v[32:33], v[32:33], v[240:241], v[32:33]
    v_pk_fma_f32 v[34:35], v[34:35], v[242:243], v[34:35]
    v_pk_fma_f32 v[36:37], v[36:37], v[244:245], v[36:37]
    v_pk_fma_f32 v[38:39], v[38:39], v[246:247], v[38:39]
    v_pk_fma_f32 v[40:41], v[40:41], v[248:249], v[40:41]
    v_pk_fma_f32 v[42:43], v[42:43], v[250:251], v[42:43]
    v_pk_fma_f32 v[44:45], v[44:45], v[252:253], v[44:45]
    v_pk_fma_f32 v[46:47], v[46:47], v[254:255], v[46:47]
    v_pk_fma_f32 v[32:33], v[224:225], v[96:97], v[32:33]
    v_pk_fma_f32 v[34:35], v[226:227], v[98:99], v[34:35]
    v_pk_fma_f32 v[36:37], v[228:229], v[100:101], v[36:37]
    v_pk_fma_f32 v[38:39], v[230:231], v[102:103], v[38:39]
    v_pk_fma_f32 v[40:41], v[232:233], v[104:105], v[40:41]
    v_pk_fma_f32 v[42:43], v[234:235], v[106:107], v[42:43]
    v_pk_fma_f32 v[44:45], v[236:237], v[108:109], v[44:45]
    v_pk_fma_f32 v[46:47], v[238:239], v[110:111], v[46:47]
    v_pk_fma_f32 v[96:97], v[96:97], v[240:241], v[96:97]
    v_pk_fma_f32 v[98:99], v[98:99], v[242:243], v[98:99]
    v_pk_fma_f32 v[100:101], v[100:101], v[244:245], v[100:101]
    v_pk_fma_f32 v[102:103], v[102:103], v[246:247], v[102:103]
    v_pk_fma_f32 v[104:105], v[104:105], v[248:249], v[104:105]
    v_pk_fma_f32 v[106:107], v[106:107], v[250:251], v[106:107]
    v_pk_fma_f32 v[108:109], v[108:109], v[252:253], v[108:109]
    v_pk_fma_f32 v[110:111], v[110:111], v[254:255], v[110:111]
    v_mfma_f32_32x32x16_bf16 v[224:239], a[60:63], a[216:219], v[192:207]
    s_mov_b64 exec, -1
    ds_read_b128 a[216:219], v12 offset:5248
    v_exp_f32 v240, v208
    v_exp_f32 v241, v209
    v_exp_f32 v242, v210
    v_mfma_f32_32x32x16_bf16 v[224:239], a[64:67], a[220:223], v[224:239]
    ds_read_b128 a[220:223], v12 offset:5280
    v_exp_f32 v243, v211
    v_exp_f32 v244, v212
    v_exp_f32 v245, v213
    v_mfma_f32_32x32x16_bf16 v[224:239], a[68:71], a[224:227], v[224:239]
    ds_read_b128 a[224:227], v12 offset:5312
    v_exp_f32 v246, v214
    v_exp_f32 v247, v215
    v_exp_f32 v248, v216
    v_mfma_f32_32x32x16_bf16 v[224:239], a[72:75], a[228:231], v[224:239]
    ds_read_b128 a[228:231], v12 offset:5344
    v_exp_f32 v249, v217
    v_exp_f32 v250, v218
    v_exp_f32 v251, v219
    v_mfma_f32_32x32x16_bf16 v[224:239], a[76:79], a[232:235], v[224:239]
    s_waitcnt lgkmcnt(2)
    ds_read_b128 a[232:235], v13 offset:9472
    v_exp_f32 v252, v220
    v_exp_f32 v253, v221
    v_exp_f32 v254, v222
    v_exp_f32_e64 v255, v223
    s_mov_b64 exec, s[42:43]
    v_pk_fma_f32 v[48:49], v[48:49], v[240:241], v[48:49]
    v_pk_fma_f32 v[50:51], v[50:51], v[242:243], v[50:51]
    v_pk_fma_f32 v[52:53], v[52:53], v[244:245], v[52:53]
    v_pk_fma_f32 v[54:55], v[54:55], v[246:247], v[54:55]
    v_pk_fma_f32 v[56:57], v[56:57], v[248:249], v[56:57]
    v_pk_fma_f32 v[58:59], v[58:59], v[250:251], v[58:59]
    v_pk_fma_f32 v[60:61], v[60:61], v[252:253], v[60:61]
    v_pk_fma_f32 v[62:63], v[62:63], v[254:255], v[62:63]
    v_pk_fma_f32 v[48:49], v[208:209], v[112:113], v[48:49]
    v_pk_fma_f32 v[50:51], v[210:211], v[114:115], v[50:51]
    v_pk_fma_f32 v[52:53], v[212:213], v[116:117], v[52:53]
    v_pk_fma_f32 v[54:55], v[214:215], v[118:119], v[54:55]
    v_pk_fma_f32 v[56:57], v[216:217], v[120:121], v[56:57]
    v_pk_fma_f32 v[58:59], v[218:219], v[122:123], v[58:59]
    v_pk_fma_f32 v[60:61], v[220:221], v[124:125], v[60:61]
    v_pk_fma_f32 v[62:63], v[222:223], v[126:127], v[62:63]
    v_pk_fma_f32 v[112:113], v[112:113], v[240:241], v[112:113]
    v_pk_fma_f32 v[114:115], v[114:115], v[242:243], v[114:115]
    v_pk_fma_f32 v[116:117], v[116:117], v[244:245], v[116:117]
    v_pk_fma_f32 v[118:119], v[118:119], v[246:247], v[118:119]
    v_pk_fma_f32 v[120:121], v[120:121], v[248:249], v[120:121]
    v_pk_fma_f32 v[122:123], v[122:123], v[250:251], v[122:123]
    v_pk_fma_f32 v[124:125], v[124:125], v[252:253], v[124:125]
    v_pk_fma_f32 v[126:127], v[126:127], v[254:255], v[126:127]
    v_mfma_f32_32x32x16_bf16 v[208:223], a[0:3], a[216:219], v[144:159]
    s_mov_b64 exec, -1
    buffer_load_dwordx4 v[2:3], s[8:11], s33 idxen offen offset:0 lds
    buffer_load_dwordx4 v[4:5], s[8:11], s34 idxen offen offset:1056 lds
    v_exp_f32 v240, v224
    v_exp_f32 v241, v225
    v_exp_f32 v242, v226
    v_mfma_f32_32x32x16_bf16 v[208:223], a[4:7], a[220:223], v[208:223]
    s_waitcnt lgkmcnt(0)
    buffer_load_dwordx4 v[6:7], s[8:11], s35 idxen offen offset:2112 lds
    buffer_load_dwordx4 v[8:9], s[8:11], 0 idxen offen offset:3168 lds
    v_exp_f32 v243, v227
    v_exp_f32 v244, v228
    v_exp_f32 v245, v229
    v_mfma_f32_32x32x16_bf16 v[208:223], a[8:11], a[224:227], v[208:223]
    s_mov_b32 m0, s66
    ds_read_u16 v2, v1 offset:768
    ds_read_u16 v4, v1 offset:800
    buffer_load_dwordx4 v[10:11], s[12:15], 0 idxen offen lds
    v_exp_f32 v246, v230
    v_exp_f32 v247, v231
    v_exp_f32 v248, v232
    v_mfma_f32_32x32x16_bf16 v[208:223], a[12:15], a[228:231], v[208:223]
    s_mov_b32 m0, s65
    ds_read_u16 v6, v1 offset:832
    ds_read_u16 v8, v1 offset:864
    ds_read_b32 v10, v0 offset:772
    v_exp_f32 v249, v233
    v_exp_f32 v250, v234
    v_exp_f32 v251, v235
    v_mfma_f32_32x32x16_bf16 v[208:223], a[16:19], a[232:235], v[208:223]
    s_mov_b64 exec, s[42:43]
    v_exp_f32 v252, v236
    v_exp_f32 v253, v237
    v_exp_f32 v254, v238
    v_exp_f32 v255, v239
    s_waitcnt lgkmcnt(0)
    v_pk_fma_f32 v[64:65], v[64:65], v[240:241], v[64:65]
    v_pk_fma_f32 v[66:67], v[66:67], v[242:243], v[66:67]
    v_pk_fma_f32 v[68:69], v[68:69], v[244:245], v[68:69]
    v_pk_fma_f32 v[70:71], v[70:71], v[246:247], v[70:71]
    v_pk_fma_f32 v[72:73], v[72:73], v[248:249], v[72:73]
    v_pk_fma_f32 v[74:75], v[74:75], v[250:251], v[74:75]
    v_pk_fma_f32 v[76:77], v[76:77], v[252:253], v[76:77]
    v_pk_fma_f32 v[78:79], v[78:79], v[254:255], v[78:79]
    v_pk_fma_f32 v[64:65], v[224:225], v[128:129], v[64:65]
    v_pk_fma_f32 v[66:67], v[226:227], v[130:131], v[66:67]
    v_pk_fma_f32 v[68:69], v[228:229], v[132:133], v[68:69]
    v_pk_fma_f32 v[70:71], v[230:231], v[134:135], v[70:71]
    v_pk_fma_f32 v[72:73], v[232:233], v[136:137], v[72:73]
    v_pk_fma_f32 v[74:75], v[234:235], v[138:139], v[74:75]
    v_pk_fma_f32 v[76:77], v[236:237], v[140:141], v[76:77]
    v_pk_fma_f32 v[78:79], v[238:239], v[142:143], v[78:79]
    v_pk_fma_f32 v[128:129], v[128:129], v[240:241], v[128:129]
    v_pk_fma_f32 v[130:131], v[130:131], v[242:243], v[130:131]
    v_pk_fma_f32 v[132:133], v[132:133], v[244:245], v[132:133]
    v_pk_fma_f32 v[134:135], v[134:135], v[246:247], v[134:135]
    v_pk_fma_f32 v[136:137], v[136:137], v[248:249], v[136:137]
    v_pk_fma_f32 v[138:139], v[138:139], v[250:251], v[138:139]
    v_pk_fma_f32 v[140:141], v[140:141], v[252:253], v[140:141]
    v_pk_fma_f32 v[142:143], v[142:143], v[254:255], v[142:143]
    s_cbranch_scc0 k2_la1
k2_lp1:
    v_mfma_f32_32x32x16_bf16 v[224:239], a[20:23], a[216:219], v[160:175]
    s_mov_b64 exec, -1
    v_exp_f32 v240, v208
    v_exp_f32 v241, v209
    v_exp_f32 v242, v210
    v_mfma_f32_32x32x16_bf16 v[224:239], a[24:27], a[220:223], v[224:239]
    v_cmp_le_u32 s[42:43], s38, v14
    v_exp_f32 v243, v211
    v_exp_f32 v244, v212
    v_exp_f32 v245, v213
    v_mfma_f32_32x32x16_bf16 v[224:239], a[28:31], a[224:227], v[224:239]
    v_exp_f32 v246, v214
    v_exp_f32 v247, v215
    v_exp_f32 v248, v216
    v_mfma_f32_32x32x16_bf16 v[224:239], a[32:35], a[228:231], v[224:239]
    v_exp_f32 v249, v217
    v_exp_f32 v250, v218
    v_exp_f32 v251, v219
    v_mfma_f32_32x32x16_bf16 v[224:239], a[36:39], a[232:235], v[224:239]
    s_mov_b64 exec, s[42:43]
    v_exp_f32 v252, v220
    v_exp_f32 v253, v221
    v_exp_f32 v254, v222
    v_exp_f32_e64 v255, v223
    v_pk_fma_f32 v[16:17], v[16:17], v[240:241], v[16:17]
    v_pk_fma_f32 v[18:19], v[18:19], v[242:243], v[18:19]
    v_pk_fma_f32 v[20:21], v[20:21], v[244:245], v[20:21]
    v_pk_fma_f32 v[22:23], v[22:23], v[246:247], v[22:23]
    v_pk_fma_f32 v[24:25], v[24:25], v[248:249], v[24:25]
    v_pk_fma_f32 v[26:27], v[26:27], v[250:251], v[26:27]
    v_pk_fma_f32 v[28:29], v[28:29], v[252:253], v[28:29]
    v_pk_fma_f32 v[30:31], v[30:31], v[254:255], v[30:31]
    v_pk_fma_f32 v[16:17], v[208:209], v[80:81], v[16:17]
    v_pk_fma_f32 v[18:19], v[210:211], v[82:83], v[18:19]
    v_pk_fma_f32 v[20:21], v[212:213], v[84:85], v[20:21]
    v_pk_fma_f32 v[22:23], v[214:215], v[86:87], v[22:23]
    v_pk_fma_f32 v[24:25], v[216:217], v[88:89], v[24:25]
    v_pk_fma_f32 v[26:27], v[218:219], v[90:91], v[26:27]
    v_pk_fma_f32 v[28:29], v[220:221], v[92:93], v[28:29]
    v_pk_fma_f32 v[30:31], v[222:223], v[94:95], v[30:31]
    v_pk_fma_f32 v[80:81], v[80:81], v[240:241], v[80:81]
    v_pk_fma_f32 v[82:83], v[82:83], v[242:243], v[82:83]
    v_pk_fma_f32 v[84:85], v[84:85], v[244:245], v[84:85]
    v_pk_fma_f32 v[86:87], v[86:87], v[246:247], v[86:87]
    v_pk_fma_f32 v[88:89], v[88:89], v[248:249], v[88:89]
    v_pk_fma_f32 v[90:91], v[90:91], v[250:251], v[90:91]
    v_pk_fma_f32 v[92:93], v[92:93], v[252:253], v[92:93]
    v_pk_fma_f32 v[94:95], v[94:95], v[254:255], v[94:95]
    v_mfma_f32_32x32x16_bf16 v[208:223], a[40:43], a[216:219], v[176:191]
    s_waitcnt vmcnt(0)
    v_exp_f32 v240, v224
    v_exp_f32 v241, v225
    v_exp_f32 v242, v226
    v_mfma_f32_32x32x16_bf16 v[208:223], a[44:47], a[220:223], v[208:223]
    s_sub_u32 s38, s38, 0x01000000
    v_exp_f32 v243, v227
    v_exp_f32 v244, v228
    v_exp_f32 v245, v229
    v_mfma_f32_32x32x16_bf16 v[208:223], a[48:51], a[224:227], v[208:223]
    s_cmp_gt_u32 s38, s37
    v_exp_f32 v246, v230
    v_exp_f32 v247, v231
    v_exp_f32 v248, v232
    v_mfma_f32_32x32x16_bf16 v[208:223], a[52:55], a[228:231], v[208:223]
    v_exp_f32 v249, v233
    v_exp_f32 v250, v234
    v_exp_f32 v251, v235
    v_mfma_f32_32x32x16_bf16 v[208:223], a[56:59], a[232:235], v[208:223]
    v_exp_f32 v252, v236
    v_exp_f32 v253, v237
    v_exp_f32 v254, v238
    v_exp_f32 v255, v239
    v_pk_fma_f32 v[32:33], v[32:33], v[240:241], v[32:33]
    v_pk_fma_f32 v[34:35], v[34:35], v[242:243], v[34:35]
    v_pk_fma_f32 v[36:37], v[36:37], v[244:245], v[36:37]
    v_pk_fma_f32 v[38:39], v[38:39], v[246:247], v[38:39]
    v_pk_fma_f32 v[40:41], v[40:41], v[248:249], v[40:41]
    v_pk_fma_f32 v[42:43], v[42:43], v[250:251], v[42:43]
    v_pk_fma_f32 v[44:45], v[44:45], v[252:253], v[44:45]
    v_pk_fma_f32 v[46:47], v[46:47], v[254:255], v[46:47]
    v_pk_fma_f32 v[32:33], v[224:225], v[96:97], v[32:33]
    v_pk_fma_f32 v[34:35], v[226:227], v[98:99], v[34:35]
    v_pk_fma_f32 v[36:37], v[228:229], v[100:101], v[36:37]
    v_pk_fma_f32 v[38:39], v[230:231], v[102:103], v[38:39]
    v_pk_fma_f32 v[40:41], v[232:233], v[104:105], v[40:41]
    v_pk_fma_f32 v[42:43], v[234:235], v[106:107], v[42:43]
    v_pk_fma_f32 v[44:45], v[236:237], v[108:109], v[44:45]
    v_pk_fma_f32 v[46:47], v[238:239], v[110:111], v[46:47]
    v_pk_fma_f32 v[96:97], v[96:97], v[240:241], v[96:97]
    v_pk_fma_f32 v[98:99], v[98:99], v[242:243], v[98:99]
    v_pk_fma_f32 v[100:101], v[100:101], v[244:245], v[100:101]
    v_pk_fma_f32 v[102:103], v[102:103], v[246:247], v[102:103]
    v_pk_fma_f32 v[104:105], v[104:105], v[248:249], v[104:105]
    v_pk_fma_f32 v[106:107], v[106:107], v[250:251], v[106:107]
    v_pk_fma_f32 v[108:109], v[108:109], v[252:253], v[108:109]
    v_pk_fma_f32 v[110:111], v[110:111], v[254:255], v[110:111]
    v_mfma_f32_32x32x16_bf16 v[224:239], a[60:63], a[216:219], v[192:207]
    s_mov_b64 exec, -1
    ds_read_b128 a[216:219], v12 offset:0
    v_exp_f32 v240, v208
    v_exp_f32 v241, v209
    v_exp_f32 v242, v210
    v_mfma_f32_32x32x16_bf16 v[224:239], a[64:67], a[220:223], v[224:239]
    ds_read_b128 a[220:223], v12 offset:32
    v_exp_f32 v243, v211
    v_exp_f32 v244, v212
    v_exp_f32 v245, v213
    v_mfma_f32_32x32x16_bf16 v[224:239], a[68:71], a[224:227], v[224:239]
    ds_read_b128 a[224:227], v12 offset:64
    v_exp_f32 v246, v214
    v_exp_f32 v247, v215
    v_exp_f32 v248, v216
    v_mfma_f32_32x32x16_bf16 v[224:239], a[72:75], a[228:231], v[224:239]
    ds_read_b128 a[228:231], v12 offset:96
    v_exp_f32 v249, v217
    v_exp_f32 v250, v218
    v_exp_f32 v251, v219
    v_mfma_f32_32x32x16_bf16 v[224:239], a[76:79], a[232:235], v[224:239]
    s_waitcnt lgkmcnt(2)
    ds_read_b128 a[232:235], v13 offset:4224
    v_exp_f32 v252, v220
    v_exp_f32 v253, v221
    v_exp_f32 v254, v222
    v_exp_f32_e64 v255, v223
    s_mov_b64 exec, s[42:43]
    v_pk_fma_f32 v[48:49], v[48:49], v[240:241], v[48:49]
    v_pk_fma_f32 v[50:51], v[50:51], v[242:243], v[50:51]
    v_pk_fma_f32 v[52:53], v[52:53], v[244:245], v[52:53]
    v_pk_fma_f32 v[54:55], v[54:55], v[246:247], v[54:55]
    v_pk_fma_f32 v[56:57], v[56:57], v[248:249], v[56:57]
    v_pk_fma_f32 v[58:59], v[58:59], v[250:251], v[58:59]
    v_pk_fma_f32 v[60:61], v[60:61], v[252:253], v[60:61]
    v_pk_fma_f32 v[62:63], v[62:63], v[254:255], v[62:63]
    v_pk_fma_f32 v[48:49], v[208:209], v[112:113], v[48:49]
    v_pk_fma_f32 v[50:51], v[210:211], v[114:115], v[50:51]
    v_pk_fma_f32 v[52:53], v[212:213], v[116:117], v[52:53]
    v_pk_fma_f32 v[54:55], v[214:215], v[118:119], v[54:55]
    v_pk_fma_f32 v[56:57], v[216:217], v[120:121], v[56:57]
    v_pk_fma_f32 v[58:59], v[218:219], v[122:123], v[58:59]
    v_pk_fma_f32 v[60:61], v[220:221], v[124:125], v[60:61]
    v_pk_fma_f32 v[62:63], v[222:223], v[126:127], v[62:63]
    v_pk_fma_f32 v[112:113], v[112:113], v[240:241], v[112:113]
    v_pk_fma_f32 v[114:115], v[114:115], v[242:243], v[114:115]
    v_pk_fma_f32 v[116:117], v[116:117], v[244:245], v[116:117]
    v_pk_fma_f32 v[118:119], v[118:119], v[246:247], v[118:119]
    v_pk_fma_f32 v[120:121], v[120:121], v[248:249], v[120:121]
    v_pk_fma_f32 v[122:123], v[122:123], v[250:251], v[122:123]
    v_pk_fma_f32 v[124:125], v[124:125], v[252:253], v[124:125]
    v_pk_fma_f32 v[126:127], v[126:127], v[254:255], v[126:127]
    v_mfma_f32_32x32x16_bf16 v[208:223], a[0:3], a[216:219], v[144:159]
    s_mov_b64 exec, -1
    buffer_load_dwordx4 v[2:3], s[8:11], s33 idxen offen offset:0 lds
    buffer_load_dwordx4 v[4:5], s[8:11], s34 idxen offen offset:1056 lds
    v_exp_f32 v240, v224
    v_exp_f32 v241, v225
    v_exp_f32 v242, v226
    v_mfma_f32_32x32x16_bf16 v[208:223], a[4:7], a[220:223], v[208:223]
    s_waitcnt lgkmcnt(0)
    buffer_load_dwordx4 v[6:7], s[8:11], s35 idxen offen offset:2112 lds
    buffer_load_dwordx4 v[8:9], s[8:11], 0 idxen offen offset:3168 lds
    v_exp_f32 v243, v227
    v_exp_f32 v244, v228
    v_exp_f32 v245, v229
    v_mfma_f32_32x32x16_bf16 v[208:223], a[8:11], a[224:227], v[208:223]
    s_mov_b32 m0, s67
    ds_read_u16 v2, v1 offset:1024
    ds_read_u16 v4, v1 offset:1056
    buffer_load_dwordx4 v[10:11], s[12:15], 0 idxen offen lds
    v_exp_f32 v246, v230
    v_exp_f32 v247, v231
    v_exp_f32 v248, v232
    v_mfma_f32_32x32x16_bf16 v[208:223], a[12:15], a[228:231], v[208:223]
    s_mov_b32 m0, s36
    ds_read_u16 v6, v1 offset:1088
    ds_read_u16 v8, v1 offset:1120
    ds_read_b32 v10, v0 offset:1028
    v_add_u32 v1, 512, v1
    v_add_u32 v0, 512, v0
    v_exp_f32 v249, v233
    v_exp_f32 v250, v234
    v_exp_f32 v251, v235
    v_mfma_f32_32x32x16_bf16 v[208:223], a[16:19], a[232:235], v[208:223]
    s_mov_b64 exec, s[42:43]
    v_exp_f32 v252, v236
    v_exp_f32 v253, v237
    v_exp_f32 v254, v238
    v_exp_f32 v255, v239
    s_waitcnt lgkmcnt(0)
    v_pk_fma_f32 v[64:65], v[64:65], v[240:241], v[64:65]
    v_pk_fma_f32 v[66:67], v[66:67], v[242:243], v[66:67]
    v_pk_fma_f32 v[68:69], v[68:69], v[244:245], v[68:69]
    v_pk_fma_f32 v[70:71], v[70:71], v[246:247], v[70:71]
    v_pk_fma_f32 v[72:73], v[72:73], v[248:249], v[72:73]
    v_pk_fma_f32 v[74:75], v[74:75], v[250:251], v[74:75]
    v_pk_fma_f32 v[76:77], v[76:77], v[252:253], v[76:77]
    v_pk_fma_f32 v[78:79], v[78:79], v[254:255], v[78:79]
    v_pk_fma_f32 v[64:65], v[224:225], v[128:129], v[64:65]
    v_pk_fma_f32 v[66:67], v[226:227], v[130:131], v[66:67]
    v_pk_fma_f32 v[68:69], v[228:229], v[132:133], v[68:69]
    v_pk_fma_f32 v[70:71], v[230:231], v[134:135], v[70:71]
    v_pk_fma_f32 v[72:73], v[232:233], v[136:137], v[72:73]
    v_pk_fma_f32 v[74:75], v[234:235], v[138:139], v[74:75]
    v_pk_fma_f32 v[76:77], v[236:237], v[140:141], v[76:77]
    v_pk_fma_f32 v[78:79], v[238:239], v[142:143], v[78:79]
    v_pk_fma_f32 v[128:129], v[128:129], v[240:241], v[128:129]
    v_pk_fma_f32 v[130:131], v[130:131], v[242:243], v[130:131]
    v_pk_fma_f32 v[132:133], v[132:133], v[244:245], v[132:133]
    v_pk_fma_f32 v[134:135], v[134:135], v[246:247], v[134:135]
    v_pk_fma_f32 v[136:137], v[136:137], v[248:249], v[136:137]
    v_pk_fma_f32 v[138:139], v[138:139], v[250:251], v[138:139]
    v_pk_fma_f32 v[140:141], v[140:141], v[252:253], v[140:141]
    v_pk_fma_f32 v[142:143], v[142:143], v[254:255], v[142:143]
    s_cbranch_scc1 k2_lp0
    s_cmp_eq_u32 s38, 0
    s_cbranch_scc1 k2_bnd
k2_la0:
    v_mfma_f32_32x32x16_bf16 v[224:239], a[20:23], a[216:219], v[160:175]
    s_mov_b64 exec, -1
    buffer_load_dwordx4 v[2:3], s[8:11], s33 idxen offen offset:0 lds
    buffer_load_dwordx4 v[4:5], s[8:11], s34 idxen offen offset:1056 lds
    v_exp_f32 v240, v208
    v_exp_f32 v241, v209
    v_exp_f32 v242, v210
    v_mfma_f32_32x32x16_bf16 v[224:239], a[24:27], a[220:223], v[224:239]
    v_cmp_le_u32 s[42:43], s38, v14
    buffer_load_dwordx4 v[6:7], s[8:11], s35 idxen offen offset:2112 lds
    v_exp_f32 v243, v211
    v_exp_f32 v244, v212
    v_exp_f32 v245, v213
    v_mfma_f32_32x32x16_bf16 v[224:239], a[28:31], a[224:227], v[224:239]
    buffer_load_dwordx4 v[8:9], s[8:11], 0 idxen offen offset:3168 lds
    v_exp_f32 v246, v214
    v_exp_f32 v247, v215
    v_exp_f32 v248, v216
    v_mfma_f32_32x32x16_bf16 v[224:239], a[32:35], a[228:231], v[224:239]
    s_mov_b32 m0, s66
    ds_read_u16 v2, v1 offset:768
    buffer_load_dwordx4 v[10:11], s[12:15], 0 idxen offen lds
    v_exp_f32 v249, v217
    v_exp_f32 v250, v218
    v_exp_f32 v251, v219
    v_mfma_f32_32x32x16_bf16 v[224:239], a[36:39], a[232:235], v[224:239]
    s_mov_b64 exec, s[42:43]
    v_exp_f32 v252, v220
    v_exp_f32 v253, v221
    v_exp_f32 v254, v222
    v_exp_f32 v255, v223
    v_pk_fma_f32 v[16:17], v[16:17], v[240:241], v[16:17]
    v_pk_fma_f32 v[18:19], v[18:19], v[242:243], v[18:19]
    v_pk_fma_f32 v[20:21], v[20:21], v[244:245], v[20:21]
    v_pk_fma_f32 v[22:23], v[22:23], v[246:247], v[22:23]
    v_pk_fma_f32 v[24:25], v[24:25], v[248:249], v[24:25]
    v_pk_fma_f32 v[26:27], v[26:27], v[250:251], v[26:27]
    v_pk_fma_f32 v[28:29], v[28:29], v[252:253], v[28:29]
    v_pk_fma_f32 v[30:31], v[30:31], v[254:255], v[30:31]
    v_pk_fma_f32 v[16:17], v[208:209], v[80:81], v[16:17]
    v_pk_fma_f32 v[18:19], v[210:211], v[82:83], v[18:19]
    v_pk_fma_f32 v[20:21], v[212:213], v[84:85], v[20:21]
    v_pk_fma_f32 v[22:23], v[214:215], v[86:87], v[22:23]
    v_pk_fma_f32 v[24:25], v[216:217], v[88:89], v[24:25]
    v_pk_fma_f32 v[26:27], v[218:219], v[90:91], v[26:27]
    v_pk_fma_f32 v[28:29], v[220:221], v[92:93], v[28:29]
    v_pk_fma_f32 v[30:31], v[222:223], v[94:95], v[30:31]
    v_pk_fma_f32 v[80:81], v[80:81], v[240:241], v[80:81]
    v_pk_fma_f32 v[82:83], v[82:83], v[242:243], v[82:83]
    v_pk_fma_f32 v[84:85], v[84:85], v[244:245], v[84:85]
    v_pk_fma_f32 v[86:87], v[86:87], v[246:247], v[86:87]
    v_pk_fma_f32 v[88:89], v[88:89], v[248:249], v[88:89]
    v_pk_fma_f32 v[90:91], v[90:91], v[250:251], v[90:91]
    v_pk_fma_f32 v[92:93], v[92:93], v[252:253], v[92:93]
    v_pk_fma_f32 v[94:95], v[94:95], v[254:255], v[94:95]
    v_mfma_f32_32x32x16_bf16 v[208:223], a[40:43], a[216:219], v[176:191]
    s_mov_b64 exec, -1
    ds_read_u16 v4, v1 offset:800
    v_exp_f32 v240, v224
    v_exp_f32 v241, v225
    v_exp_f32 v242, v226
    v_mfma_f32_32x32x16_bf16 v[208:223], a[44:47], a[220:223], v[208:223]
    s_mov_b32 m0, s65
    ds_read_u16 v6, v1 offset:832
    v_exp_f32 v243, v227
    v_exp_f32 v244, v228
    v_exp_f32 v245, v229
    v_mfma_f32_32x32x16_bf16 v[208:223], a[48:51], a[224:227], v[208:223]
    ds_read_u16 v8, v1 offset:864
    v_exp_f32 v246, v230
    v_exp_f32 v247, v231
    v_exp_f32 v248, v232
    v_mfma_f32_32x32x16_bf16 v[208:223], a[52:55], a[228:231], v[208:223]
    ds_read_b32 v10, v0 offset:772
    v_exp_f32 v249, v233
    v_exp_f32 v250, v234
    v_exp_f32 v251, v235
    v_mfma_f32_32x32x16_bf16 v[208:223], a[56:59], a[232:235], v[208:223]
    s_mov_b64 exec, s[42:43]
    v_exp_f32 v252, v236
    v_exp_f32 v253, v237
    v_exp_f32 v254, v238
    v_exp_f32 v255, v239
    s_waitcnt vmcnt(5)
    v_pk_fma_f32 v[32:33], v[32:33], v[240:241], v[32:33]
    v_pk_fma_f32 v[34:35], v[34:35], v[242:243], v[34:35]
    v_pk_fma_f32 v[36:37], v[36:37], v[244:245], v[36:37]
    v_pk_fma_f32 v[38:39], v[38:39], v[246:247], v[38:39]
    v_pk_fma_f32 v[40:41], v[40:41], v[248:249], v[40:41]
    v_pk_fma_f32 v[42:43], v[42:43], v[250:251], v[42:43]
    v_pk_fma_f32 v[44:45], v[44:45], v[252:253], v[44:45]
    v_pk_fma_f32 v[46:47], v[46:47], v[254:255], v[46:47]
    v_pk_fma_f32 v[32:33], v[224:225], v[96:97], v[32:33]
    v_pk_fma_f32 v[34:35], v[226:227], v[98:99], v[34:35]
    v_pk_fma_f32 v[36:37], v[228:229], v[100:101], v[36:37]
    v_pk_fma_f32 v[38:39], v[230:231], v[102:103], v[38:39]
    v_pk_fma_f32 v[40:41], v[232:233], v[104:105], v[40:41]
    v_pk_fma_f32 v[42:43], v[234:235], v[106:107], v[42:43]
    v_pk_fma_f32 v[44:45], v[236:237], v[108:109], v[44:45]
    v_pk_fma_f32 v[46:47], v[238:239], v[110:111], v[46:47]
    v_pk_fma_f32 v[96:97], v[96:97], v[240:241], v[96:97]
    v_pk_fma_f32 v[98:99], v[98:99], v[242:243], v[98:99]
    v_pk_fma_f32 v[100:101], v[100:101], v[244:245], v[100:101]
    v_pk_fma_f32 v[102:103], v[102:103], v[246:247], v[102:103]
    v_pk_fma_f32 v[104:105], v[104:105], v[248:249], v[104:105]
    v_pk_fma_f32 v[106:107], v[106:107], v[250:251], v[106:107]
    v_pk_fma_f32 v[108:109], v[108:109], v[252:253], v[108:109]
    v_pk_fma_f32 v[110:111], v[110:111], v[254:255], v[110:111]
    v_mfma_f32_32x32x16_bf16 v[224:239], a[60:63], a[216:219], v[192:207]
    s_mov_b64 exec, -1
    ds_read_b128 a[216:219], v12 offset:5248
    v_exp_f32 v240, v208
    v_exp_f32 v241, v209
    v_exp_f32 v242, v210
    v_mfma_f32_32x32x16_bf16 v[224:239], a[64:67], a[220:223], v[224:239]
    ds_read_b128 a[220:223], v12 offset:5280
    v_exp_f32 v243, v211
    v_exp_f32 v244, v212
    v_exp_f32 v245, v213
    v_mfma_f32_32x32x16_bf16 v[224:239], a[68:71], a[224:227], v[224:239]
    ds_read_b128 a[224:227], v12 offset:5312
    v_exp_f32 v246, v214
    v_exp_f32 v247, v215
    v_exp_f32 v248, v216
    v_mfma_f32_32x32x16_bf16 v[224:239], a[72:75], a[228:231], v[224:239]
    ds_read_b128 a[228:231], v12 offset:5344
    v_exp_f32 v249, v217
    v_exp_f32 v250, v218
    v_exp_f32 v251, v219
    v_mfma_f32_32x32x16_bf16 v[224:239], a[76:79], a[232:235], v[224:239]
    s_waitcnt lgkmcnt(2)
    ds_read_b128 a[232:235], v13 offset:9472
    v_exp_f32 v252, v220
    v_exp_f32 v253, v221
    v_exp_f32 v254, v222
    v_exp_f32_e64 v255, v223
    s_mov_b64 exec, s[42:43]
    v_pk_fma_f32 v[48:49], v[48:49], v[240:241], v[48:49]
    v_pk_fma_f32 v[50:51], v[50:51], v[242:243], v[50:51]
    v_pk_fma_f32 v[52:53], v[52:53], v[244:245], v[52:53]
    v_pk_fma_f32 v[54:55], v[54:55], v[246:247], v[54:55]
    v_pk_fma_f32 v[56:57], v[56:57], v[248:249], v[56:57]
    v_pk_fma_f32 v[58:59], v[58:59], v[250:251], v[58:59]
    v_pk_fma_f32 v[60:61], v[60:61], v[252:253], v[60:61]
    v_pk_fma_f32 v[62:63], v[62:63], v[254:255], v[62:63]
    v_pk_fma_f32 v[48:49], v[208:209], v[112:113], v[48:49]
    v_pk_fma_f32 v[50:51], v[210:211], v[114:115], v[50:51]
    v_pk_fma_f32 v[52:53], v[212:213], v[116:117], v[52:53]
    v_pk_fma_f32 v[54:55], v[214:215], v[118:119], v[54:55]
    v_pk_fma_f32 v[56:57], v[216:217], v[120:121], v[56:57]
    v_pk_fma_f32 v[58:59], v[218:219], v[122:123], v[58:59]
    v_pk_fma_f32 v[60:61], v[220:221], v[124:125], v[60:61]
    v_pk_fma_f32 v[62:63], v[222:223], v[126:127], v[62:63]
    v_pk_fma_f32 v[112:113], v[112:113], v[240:241], v[112:113]
    v_pk_fma_f32 v[114:115], v[114:115], v[242:243], v[114:115]
    v_pk_fma_f32 v[116:117], v[116:117], v[244:245], v[116:117]
    v_pk_fma_f32 v[118:119], v[118:119], v[246:247], v[118:119]
    v_pk_fma_f32 v[120:121], v[120:121], v[248:249], v[120:121]
    v_pk_fma_f32 v[122:123], v[122:123], v[250:251], v[122:123]
    v_pk_fma_f32 v[124:125], v[124:125], v[252:253], v[124:125]
    v_pk_fma_f32 v[126:127], v[126:127], v[254:255], v[126:127]
    v_mfma_f32_32x32x16_bf16 v[208:223], a[0:3], a[216:219], v[144:159]
    s_mov_b64 exec, -1
    v_exp_f32 v240, v224
    v_exp_f32 v241, v225
    v_exp_f32 v242, v226
    v_mfma_f32_32x32x16_bf16 v[208:223], a[4:7], a[220:223], v[208:223]
    s_waitcnt lgkmcnt(0)
    v_exp_f32 v243, v227
    v_exp_f32 v244, v228
    v_exp_f32 v245, v229
    v_mfma_f32_32x32x16_bf16 v[208:223], a[8:11], a[224:227], v[208:223]
    s_sub_u32 s38, s38, 0x01000000
    v_exp_f32 v246, v230
    v_exp_f32 v247, v231
    v_exp_f32 v248, v232
    v_mfma_f32_32x32x16_bf16 v[208:223], a[12:15], a[228:231], v[208:223]
    v_exp_f32 v249, v233
    v_exp_f32 v250, v234
    v_exp_f32 v251, v235
    v_mfma_f32_32x32x16_bf16 v[208:223], a[16:19], a[232:235], v[208:223]
    s_mov_b64 exec, s[42:43]
    v_exp_f32 v252, v236
    v_exp_f32 v253, v237
    v_exp_f32 v254, v238
    v_exp_f32_e64 v255, v239
    v_pk_fma_f32 v[64:65], v[64:65], v[240:241], v[64:65]
    v_pk_fma_f32 v[66:67], v[66:67], v[242:243], v[66:67]
    v_pk_fma_f32 v[68:69], v[68:69], v[244:245], v[68:69]
    v_pk_fma_f32 v[70:71], v[70:71], v[246:247], v[70:71]
    v_pk_fma_f32 v[72:73], v[72:73], v[248:249], v[72:73]
    v_pk_fma_f32 v[74:75], v[74:75], v[250:251], v[74:75]
    v_pk_fma_f32 v[76:77], v[76:77], v[252:253], v[76:77]
    v_pk_fma_f32 v[78:79], v[78:79], v[254:255], v[78:79]
    v_pk_fma_f32 v[64:65], v[224:225], v[128:129], v[64:65]
    v_pk_fma_f32 v[66:67], v[226:227], v[130:131], v[66:67]
    v_pk_fma_f32 v[68:69], v[228:229], v[132:133], v[68:69]
    v_pk_fma_f32 v[70:71], v[230:231], v[134:135], v[70:71]
    v_pk_fma_f32 v[72:73], v[232:233], v[136:137], v[72:73]
    v_pk_fma_f32 v[74:75], v[234:235], v[138:139], v[74:75]
    v_pk_fma_f32 v[76:77], v[236:237], v[140:141], v[76:77]
    v_pk_fma_f32 v[78:79], v[238:239], v[142:143], v[78:79]
    v_pk_fma_f32 v[128:129], v[128:129], v[240:241], v[128:129]
    v_pk_fma_f32 v[130:131], v[130:131], v[242:243], v[130:131]
    v_pk_fma_f32 v[132:133], v[132:133], v[244:245], v[132:133]
    v_pk_fma_f32 v[134:135], v[134:135], v[246:247], v[134:135]
    v_pk_fma_f32 v[136:137], v[136:137], v[248:249], v[136:137]
    v_pk_fma_f32 v[138:139], v[138:139], v[250:251], v[138:139]
    v_pk_fma_f32 v[140:141], v[140:141], v[252:253], v[140:141]
    v_pk_fma_f32 v[142:143], v[142:143], v[254:255], v[142:143]
k2_la1:
    v_mfma_f32_32x32x16_bf16 v[224:239], a[20:23], a[216:219], v[160:175]
    s_mov_b64 exec, -1
    buffer_load_dwordx4 v[2:3], s[8:11], s33 idxen offen offset:0 lds
    buffer_load_dwordx4 v[4:5], s[8:11], s34 idxen offen offset:1056 lds
    v_exp_f32 v240, v208
    v_exp_f32 v241, v209
    v_exp_f32 v242, v210
    v_mfma_f32_32x32x16_bf16 v[224:239], a[24:27], a[220:223], v[224:239]
    v_cmp_le_u32 s[42:43], s38, v14
    buffer_load_dwordx4 v[6:7], s[8:11], s35 idxen offen offset:2112 lds
    v_exp_f32 v243, v211
    v_exp_f32 v244, v212
    v_exp_f32 v245, v213
    v_mfma_f32_32x32x16_bf16 v[224:239], a[28:31], a[224:227], v[224:239]
    buffer_load_dwordx4 v[8:9], s[8:11], 0 idxen offen offset:3168 lds
    v_exp_f32 v246, v214
    v_exp_f32 v247, v215
    v_exp_f32 v248, v216
    v_mfma_f32_32x32x16_bf16 v[224:239], a[32:35], a[228:231], v[224:239]
    s_mov_b32 m0, s67
    ds_read_u16 v2, v1 offset:1024
    buffer_load_dwordx4 v[10:11], s[12:15], 0 idxen offen lds
    v_exp_f32 v249, v217
    v_exp_f32 v250, v218
    v_exp_f32 v251, v219
    v_mfma_f32_32x32x16_bf16 v[224:239], a[36:39], a[232:235], v[224:239]
    s_mov_b64 exec, s[42:43]
    v_exp_f32 v252, v220
    v_exp_f32 v253, v221
    v_exp_f32 v254, v222
    v_exp_f32_e64 v255, v223
    v_pk_fma_f32 v[16:17], v[16:17], v[240:241], v[16:17]
    v_pk_fma_f32 v[18:19], v[18:19], v[242:243], v[18:19]
    v_pk_fma_f32 v[20:21], v[20:21], v[244:245], v[20:21]
    v_pk_fma_f32 v[22:23], v[22:23], v[246:247], v[22:23]
    v_pk_fma_f32 v[24:25], v[24:25], v[248:249], v[24:25]
    v_pk_fma_f32 v[26:27], v[26:27], v[250:251], v[26:27]
    v_pk_fma_f32 v[28:29], v[28:29], v[252:253], v[28:29]
    v_pk_fma_f32 v[30:31], v[30:31], v[254:255], v[30:31]
    v_pk_fma_f32 v[16:17], v[208:209], v[80:81], v[16:17]
    v_pk_fma_f32 v[18:19], v[210:211], v[82:83], v[18:19]
    v_pk_fma_f32 v[20:21], v[212:213], v[84:85], v[20:21]
    v_pk_fma_f32 v[22:23], v[214:215], v[86:87], v[22:23]
    v_pk_fma_f32 v[24:25], v[216:217], v[88:89], v[24:25]
    v_pk_fma_f32 v[26:27], v[218:219], v[90:91], v[26:27]
    v_pk_fma_f32 v[28:29], v[220:221], v[92:93], v[28:29]
    v_pk_fma_f32 v[30:31], v[222:223], v[94:95], v[30:31]
    v_pk_fma_f32 v[80:81], v[80:81], v[240:241], v[80:81]
    v_pk_fma_f32 v[82:83], v[82:83], v[242:243], v[82:83]
    v_pk_fma_f32 v[84:85], v[84:85], v[244:245], v[84:85]
    v_pk_fma_f32 v[86:87], v[86:87], v[246:247], v[86:87]
    v_pk_fma_f32 v[88:89], v[88:89], v[248:249], v[88:89]
    v_pk_fma_f32 v[90:91], v[90:91], v[250:251], v[90:91]
    v_pk_fma_f32 v[92:93], v[92:93], v[252:253], v[92:93]
    v_pk_fma_f32 v[94:95], v[94:95], v[254:255], v[94:95]
    v_mfma_f32_32x32x16_bf16 v[208:223], a[40:43], a[216:219], v[176:191]
    s_mov_b64 exec, -1
    ds_read_u16 v4, v1 offset:1056
    v_exp_f32 v240, v224
    v_exp_f32 v241, v225
    v_exp_f32 v242, v226
    v_mfma_f32_32x32x16_bf16 v[208:223], a[44:47], a[220:223], v[208:223]
    s_mov_b32 m0, s36
    ds_read_u16 v6, v1 offset:1088
    v_exp_f32 v243, v227
    v_exp_f32 v244, v228
    v_exp_f32 v245, v229
    v_mfma_f32_32x32x16_bf16 v[208:223], a[48:51], a[224:227], v[208:223]
    ds_read_u16 v8, v1 offset:1120
    v_exp_f32 v246, v230
    v_exp_f32 v247, v231
    v_exp_f32 v248, v232
    v_mfma_f32_32x32x16_bf16 v[208:223], a[52:55], a[228:231], v[208:223]
    ds_read_b32 v10, v0 offset:1028
    v_exp_f32 v249, v233
    v_exp_f32 v250, v234
    v_exp_f32 v251, v235
    v_mfma_f32_32x32x16_bf16 v[208:223], a[56:59], a[232:235], v[208:223]
    s_mov_b64 exec, s[42:43]
    v_exp_f32 v252, v236
    v_exp_f32 v253, v237
    v_exp_f32 v254, v238
    v_exp_f32 v255, v239
    s_waitcnt vmcnt(5)
    v_pk_fma_f32 v[32:33], v[32:33], v[240:241], v[32:33]
    v_pk_fma_f32 v[34:35], v[34:35], v[242:243], v[34:35]
    v_pk_fma_f32 v[36:37], v[36:37], v[244:245], v[36:37]
    v_pk_fma_f32 v[38:39], v[38:39], v[246:247], v[38:39]
    v_pk_fma_f32 v[40:41], v[40:41], v[248:249], v[40:41]
    v_pk_fma_f32 v[42:43], v[42:43], v[250:251], v[42:43]
    v_pk_fma_f32 v[44:45], v[44:45], v[252:253], v[44:45]
    v_pk_fma_f32 v[46:47], v[46:47], v[254:255], v[46:47]
    v_pk_fma_f32 v[32:33], v[224:225], v[96:97], v[32:33]
    v_pk_fma_f32 v[34:35], v[226:227], v[98:99], v[34:35]
    v_pk_fma_f32 v[36:37], v[228:229], v[100:101], v[36:37]
    v_pk_fma_f32 v[38:39], v[230:231], v[102:103], v[38:39]
    v_pk_fma_f32 v[40:41], v[232:233], v[104:105], v[40:41]
    v_pk_fma_f32 v[42:43], v[234:235], v[106:107], v[42:43]
    v_pk_fma_f32 v[44:45], v[236:237], v[108:109], v[44:45]
    v_pk_fma_f32 v[46:47], v[238:239], v[110:111], v[46:47]
    v_pk_fma_f32 v[96:97], v[96:97], v[240:241], v[96:97]
    v_pk_fma_f32 v[98:99], v[98:99], v[242:243], v[98:99]
    v_pk_fma_f32 v[100:101], v[100:101], v[244:245], v[100:101]
    v_pk_fma_f32 v[102:103], v[102:103], v[246:247], v[102:103]
    v_pk_fma_f32 v[104:105], v[104:105], v[248:249], v[104:105]
    v_pk_fma_f32 v[106:107], v[106:107], v[250:251], v[106:107]
    v_pk_fma_f32 v[108:109], v[108:109], v[252:253], v[108:109]
    v_pk_fma_f32 v[110:111], v[110:111], v[254:255], v[110:111]
    v_mfma_f32_32x32x16_bf16 v[224:239], a[60:63], a[216:219], v[192:207]
    s_mov_b64 exec, -1
    ds_read_b128 a[216:219], v12 offset:0
    v_exp_f32 v240, v208
    v_exp_f32 v241, v209
    v_exp_f32 v242, v210
    v_mfma_f32_32x32x16_bf16 v[224:239], a[64:67], a[220:223], v[224:239]
    ds_read_b128 a[220:223], v12 offset:32
    v_exp_f32 v243, v211
    v_exp_f32 v244, v212
    v_exp_f32 v245, v213
    v_mfma_f32_32x32x16_bf16 v[224:239], a[68:71], a[224:227], v[224:239]
    ds_read_b128 a[224:227], v12 offset:64
    v_exp_f32 v246, v214
    v_exp_f32 v247, v215
    v_exp_f32 v248, v216
    v_mfma_f32_32x32x16_bf16 v[224:239], a[72:75], a[228:231], v[224:239]
    ds_read_b128 a[228:231], v12 offset:96
    v_exp_f32 v249, v217
    v_exp_f32 v250, v218
    v_exp_f32 v251, v219
    v_mfma_f32_32x32x16_bf16 v[224:239], a[76:79], a[232:235], v[224:239]
    s_waitcnt lgkmcnt(2)
    ds_read_b128 a[232:235], v13 offset:4224
    v_exp_f32 v252, v220
    v_exp_f32 v253, v221
    v_exp_f32 v254, v222
    v_exp_f32_e64 v255, v223
    s_mov_b64 exec, s[42:43]
    v_pk_fma_f32 v[48:49], v[48:49], v[240:241], v[48:49]
    v_pk_fma_f32 v[50:51], v[50:51], v[242:243], v[50:51]
    v_pk_fma_f32 v[52:53], v[52:53], v[244:245], v[52:53]
    v_pk_fma_f32 v[54:55], v[54:55], v[246:247], v[54:55]
    v_pk_fma_f32 v[56:57], v[56:57], v[248:249], v[56:57]
    v_pk_fma_f32 v[58:59], v[58:59], v[250:251], v[58:59]
    v_pk_fma_f32 v[60:61], v[60:61], v[252:253], v[60:61]
    v_pk_fma_f32 v[62:63], v[62:63], v[254:255], v[62:63]
    v_pk_fma_f32 v[48:49], v[208:209], v[112:113], v[48:49]
    v_pk_fma_f32 v[50:51], v[210:211], v[114:115], v[50:51]
    v_pk_fma_f32 v[52:53], v[212:213], v[116:117], v[52:53]
    v_pk_fma_f32 v[54:55], v[214:215], v[118:119], v[54:55]
    v_pk_fma_f32 v[56:57], v[216:217], v[120:121], v[56:57]
    v_pk_fma_f32 v[58:59], v[218:219], v[122:123], v[58:59]
    v_pk_fma_f32 v[60:61], v[220:221], v[124:125], v[60:61]
    v_pk_fma_f32 v[62:63], v[222:223], v[126:127], v[62:63]
    v_pk_fma_f32 v[112:113], v[112:113], v[240:241], v[112:113]
    v_pk_fma_f32 v[114:115], v[114:115], v[242:243], v[114:115]
    v_pk_fma_f32 v[116:117], v[116:117], v[244:245], v[116:117]
    v_pk_fma_f32 v[118:119], v[118:119], v[246:247], v[118:119]
    v_pk_fma_f32 v[120:121], v[120:121], v[248:249], v[120:121]
    v_pk_fma_f32 v[122:123], v[122:123], v[250:251], v[122:123]
    v_pk_fma_f32 v[124:125], v[124:125], v[252:253], v[124:125]
    v_pk_fma_f32 v[126:127], v[126:127], v[254:255], v[126:127]
    v_mfma_f32_32x32x16_bf16 v[208:223], a[0:3], a[216:219], v[144:159]
    s_mov_b64 exec, -1
    v_exp_f32 v240, v224
    v_exp_f32 v241, v225
    v_exp_f32 v242, v226
    v_mfma_f32_32x32x16_bf16 v[208:223], a[4:7], a[220:223], v[208:223]
    s_waitcnt lgkmcnt(0)
    v_add_u32 v1, 512, v1
    v_add_u32 v0, 512, v0
    v_exp_f32 v243, v227
    v_exp_f32 v244, v228
    v_exp_f32 v245, v229
    v_mfma_f32_32x32x16_bf16 v[208:223], a[8:11], a[224:227], v[208:223]
    s_sub_u32 s38, s38, 0x01000000
    v_exp_f32 v246, v230
    v_exp_f32 v247, v231
    v_exp_f32 v248, v232
    v_mfma_f32_32x32x16_bf16 v[208:223], a[12:15], a[228:231], v[208:223]
    s_cmp_lg_u32 s38, 0
    v_exp_f32 v249, v233
    v_exp_f32 v250, v234
    v_exp_f32 v251, v235
    v_mfma_f32_32x32x16_bf16 v[208:223], a[16:19], a[232:235], v[208:223]
    s_mov_b64 exec, s[42:43]
    v_exp_f32 v252, v236
    v_exp_f32 v253, v237
    v_exp_f32 v254, v238
    v_exp_f32 v255, v239
    v_pk_fma_f32 v[64:65], v[64:65], v[240:241], v[64:65]
    v_pk_fma_f32 v[66:67], v[66:67], v[242:243], v[66:67]
    v_pk_fma_f32 v[68:69], v[68:69], v[244:245], v[68:69]
    v_pk_fma_f32 v[70:71], v[70:71], v[246:247], v[70:71]
    v_pk_fma_f32 v[72:73], v[72:73], v[248:249], v[72:73]
    v_pk_fma_f32 v[74:75], v[74:75], v[250:251], v[74:75]
    v_pk_fma_f32 v[76:77], v[76:77], v[252:253], v[76:77]
    v_pk_fma_f32 v[78:79], v[78:79], v[254:255], v[78:79]
    v_pk_fma_f32 v[64:65], v[224:225], v[128:129], v[64:65]
    v_pk_fma_f32 v[66:67], v[226:227], v[130:131], v[66:67]
    v_pk_fma_f32 v[68:69], v[228:229], v[132:133], v[68:69]
    v_pk_fma_f32 v[70:71], v[230:231], v[134:135], v[70:71]
    v_pk_fma_f32 v[72:73], v[232:233], v[136:137], v[72:73]
    v_pk_fma_f32 v[74:75], v[234:235], v[138:139], v[74:75]
    v_pk_fma_f32 v[76:77], v[236:237], v[140:141], v[76:77]
    v_pk_fma_f32 v[78:79], v[238:239], v[142:143], v[78:79]
    v_pk_fma_f32 v[128:129], v[128:129], v[240:241], v[128:129]
    v_pk_fma_f32 v[130:131], v[130:131], v[242:243], v[130:131]
    v_pk_fma_f32 v[132:133], v[132:133], v[244:245], v[132:133]
    v_pk_fma_f32 v[134:135], v[134:135], v[246:247], v[134:135]
    v_pk_fma_f32 v[136:137], v[136:137], v[248:249], v[136:137]
    v_pk_fma_f32 v[138:139], v[138:139], v[250:251], v[138:139]
    v_pk_fma_f32 v[140:141], v[140:141], v[252:253], v[140:141]
    v_pk_fma_f32 v[142:143], v[142:143], v[254:255], v[142:143]
    s_cbranch_scc1 k2_la0
k2_bnd:
    s_mov_b64 exec, -1
    s_cmp_lg_u32 s28, 3
    s_cbranch_scc1 k2_notk_a
    s_mov_b64 exec, 1
    v_mov_b32 v15, 0
    global_atomic_add a239, v15, a239, s[68:69] sc0
    s_mov_b64 exec, -1
k2_notk_a:
    v_accvgpr_read_b32 v240, a237
    v_cvt_f32_ubyte3 v248, v14
    v_mov_b32 v249, 0
    v_mov_b32 v250, 0
    v_cvt_pk_bf16_f32 v248, v248, v248
    v_mov_b32 v251, 0
    v_max_f32 v15, v80, v81
    v_max3_f32 v15, v82, v83, v15
    v_mfma_f32_32x32x16_bf16 v[208:223], a[208:211], v[248:251], 0
    buffer_load_dwordx4 v[2:3], s[8:11], s33 idxen offen offset:0 lds
    buffer_load_dwordx4 v[4:5], s[8:11], s34 idxen offen offset:1056 lds
    buffer_load_dwordx4 v[6:7], s[8:11], s35 idxen offen offset:2112 lds
    buffer_load_dwordx4 v[8:9], s[8:11], 0 idxen offen offset:3168 lds
    s_mov_b32 m0, s66
    ds_read_b128 v[144:147], v240 offset:0
    buffer_load_dwordx4 v[10:11], s[12:15], 0 idxen offen lds
    v_max3_f32 v15, v84, v85, v15
    v_max3_f32 v15, v86, v87, v15
    v_max3_f32 v15, v88, v89, v15
    v_max3_f32 v15, v90, v91, v15
    v_max3_f32 v15, v92, v93, v15
    v_max3_f32 v15, v94, v95, v15
    v_rcp_f32 v80, v80
    v_rcp_f32 v81, v81
    v_rcp_f32 v82, v82
    v_rcp_f32 v83, v83
    v_mfma_f32_32x32x16_bf16 v[224:239], a[212:215], v[248:251], 0
    s_mov_b32 m0, s65
    ds_read_b128 v[148:151], v240 offset:1024
    ds_read_b128 v[152:155], v240 offset:2048
    ds_read_b128 v[156:159], v240 offset:3072
    ds_read_b128 v[160:163], v240 offset:4096
    ds_read_b128 v[164:167], v240 offset:5120
    ds_read_b128 v[168:171], v240 offset:6144
    ds_read_b128 v[172:175], v240 offset:7168
    ds_read_b128 v[176:179], v240 offset:8192
    ds_read_b128 v[180:183], v240 offset:9216
    ds_read_b128 v[184:187], v240 offset:10240
    ds_read_b128 v[188:191], v240 offset:11264
    ds_read_b128 v[192:195], v240 offset:12288
    ds_read_b128 v[196:199], v240 offset:13312
    ds_read_b128 v[200:203], v240 offset:14336
    ds_read_b128 v[204:207], v240 offset:15360
    v_rcp_f32 v84, v84
    v_rcp_f32 v85, v85
    v_rcp_f32 v86, v86
    v_rcp_f32 v87, v87
    v_rcp_f32 v88, v88
    v_rcp_f32 v89, v89
    v_rcp_f32 v90, v90
    v_rcp_f32 v91, v91
    v_rcp_f32 v92, v92
    v_rcp_f32 v93, v93
    v_rcp_f32 v94, v94
    v_rcp_f32 v95, v95
    v_pk_mul_f32 v[16:17], v[16:17], v[80:81]
    v_pk_mul_f32 v[18:19], v[18:19], v[82:83]
    v_pk_mul_f32 v[20:21], v[20:21], v[84:85]
    v_pk_mul_f32 v[22:23], v[22:23], v[86:87]
    v_pk_mul_f32 v[24:25], v[24:25], v[88:89]
    v_pk_mul_f32 v[26:27], v[26:27], v[90:91]
    v_pk_mul_f32 v[28:29], v[28:29], v[92:93]
    v_pk_mul_f32 v[30:31], v[30:31], v[94:95]
    v_cvt_pk_bf16_f32 v240, v16, v17
    v_cvt_pk_bf16_f32 v241, v18, v19
    v_cvt_pk_bf16_f32 v242, v20, v21
    v_cvt_pk_bf16_f32 v243, v22, v23
    v_cvt_pk_bf16_f32 v244, v24, v25
    v_cvt_pk_bf16_f32 v245, v26, v27
    v_cvt_pk_bf16_f32 v246, v28, v29
    v_cvt_pk_bf16_f32 v247, v30, v31
    v_max3_f32 v15, v96, v97, v15
    v_max3_f32 v15, v98, v99, v15
    v_mfma_f32_32x32x16_bf16 v[208:223], a[144:147], v[240:243], v[208:223]
    s_waitcnt lgkmcnt(0)
    v_max3_f32 v15, v100, v101, v15
    v_max3_f32 v15, v102, v103, v15
    v_max3_f32 v15, v104, v105, v15
    v_max3_f32 v15, v106, v107, v15
    v_max3_f32 v15, v108, v109, v15
    v_max3_f32 v15, v110, v111, v15
    v_rcp_f32 v96, v96
    v_mfma_f32_32x32x16_bf16 v[224:239], a[148:151], v[240:243], v[224:239]
    v_rcp_f32 v97, v97
    v_rcp_f32 v98, v98
    v_rcp_f32 v99, v99
    v_mfma_f32_32x32x16_bf16 v[208:223], a[152:155], v[244:247], v[208:223]
    v_rcp_f32 v100, v100
    v_rcp_f32 v101, v101
    v_rcp_f32 v102, v102
    v_rcp_f32 v103, v103
    v_mfma_f32_32x32x16_bf16 v[224:239], a[156:159], v[244:247], v[224:239]
    v_rcp_f32 v104, v104
    v_rcp_f32 v105, v105
    v_rcp_f32 v106, v106
    v_mfma_f32_32x32x16_bf16 v[16:31], a[0:3], a[216:219], v[144:159]
    v_rcp_f32 v107, v107
    v_rcp_f32 v108, v108
    v_rcp_f32 v109, v109
    v_rcp_f32 v110, v110
    v_rcp_f32_e64 v111, v111
    v_pk_mul_f32 v[32:33], v[32:33], v[96:97]
    v_pk_mul_f32 v[34:35], v[34:35], v[98:99]
    v_pk_mul_f32 v[36:37], v[36:37], v[100:101]
    v_pk_mul_f32 v[38:39], v[38:39], v[102:103]
    v_pk_mul_f32 v[40:41], v[40:41], v[104:105]
    v_pk_mul_f32 v[42:43], v[42:43], v[106:107]
    v_pk_mul_f32 v[44:45], v[44:45], v[108:109]
    v_pk_mul_f32 v[46:47], v[46:47], v[110:111]
    v_mfma_f32_32x32x16_bf16 v[16:31], a[4:7], a[220:223], v[16:31]
    v_cvt_pk_bf16_f32 v248, v32, v33
    v_cvt_pk_bf16_f32 v249, v34, v35
    v_cvt_pk_bf16_f32 v250, v36, v37
    v_cvt_pk_bf16_f32 v251, v38, v39
    v_cvt_pk_bf16_f32 v252, v40, v41
    v_cvt_pk_bf16_f32 v253, v42, v43
    v_cvt_pk_bf16_f32 v254, v44, v45
    v_cvt_pk_bf16_f32 v255, v46, v47
    v_max3_f32 v15, v112, v113, v15
    v_max3_f32 v15, v114, v115, v15
    v_mfma_f32_32x32x16_bf16 v[208:223], a[160:163], v[248:251], v[208:223]
    v_max3_f32 v15, v116, v117, v15
    v_max3_f32 v15, v118, v119, v15
    v_max3_f32 v15, v120, v121, v15
    v_max3_f32 v15, v122, v123, v15
    v_max3_f32 v15, v124, v125, v15
    v_max3_f32 v15, v126, v127, v15
    v_rcp_f32 v112, v112
    v_mfma_f32_32x32x16_bf16 v[224:239], a[164:167], v[248:251], v[224:239]
    v_rcp_f32 v113, v113
    v_rcp_f32 v114, v114
    v_rcp_f32 v115, v115
    v_mfma_f32_32x32x16_bf16 v[208:223], a[168:171], v[252:255], v[208:223]
    v_rcp_f32 v116, v116
    v_rcp_f32 v117, v117
    v_rcp_f32 v118, v118
    v_rcp_f32 v119, v119
    v_mfma_f32_32x32x16_bf16 v[224:239], a[172:175], v[252:255], v[224:239]
    v_rcp_f32 v120, v120
    v_rcp_f32 v121, v121
    v_rcp_f32 v122, v122
    v_mfma_f32_32x32x16_bf16 v[16:31], a[8:11], a[224:227], v[16:31]
    v_rcp_f32 v123, v123
    v_rcp_f32 v124, v124
    v_rcp_f32 v125, v125
    v_rcp_f32 v126, v126
    v_rcp_f32 v127, v127
    v_pk_mul_f32 v[48:49], v[48:49], v[112:113]
    v_pk_mul_f32 v[50:51], v[50:51], v[114:115]
    v_pk_mul_f32 v[52:53], v[52:53], v[116:117]
    v_pk_mul_f32 v[54:55], v[54:55], v[118:119]
    v_pk_mul_f32 v[56:57], v[56:57], v[120:121]
    v_pk_mul_f32 v[58:59], v[58:59], v[122:123]
    v_pk_mul_f32 v[60:61], v[60:61], v[124:125]
    v_pk_mul_f32 v[62:63], v[62:63], v[126:127]
    v_mfma_f32_32x32x16_bf16 v[16:31], a[12:15], a[228:231], v[16:31]
    v_cvt_pk_bf16_f32 v240, v48, v49
    v_cvt_pk_bf16_f32 v241, v50, v51
    v_cvt_pk_bf16_f32 v242, v52, v53
    v_cvt_pk_bf16_f32 v243, v54, v55
    v_cvt_pk_bf16_f32 v244, v56, v57
    v_cvt_pk_bf16_f32 v245, v58, v59
    v_cvt_pk_bf16_f32 v246, v60, v61
    v_cvt_pk_bf16_f32 v247, v62, v63
    v_max3_f32 v15, v128, v129, v15
    v_max3_f32 v15, v130, v131, v15
    v_mfma_f32_32x32x16_bf16 v[208:223], a[176:179], v[240:243], v[208:223]
    v_max3_f32 v15, v132, v133, v15
    v_max3_f32 v15, v134, v135, v15
    v_max3_f32 v15, v136, v137, v15
    v_max3_f32 v15, v138, v139, v15
    v_max3_f32 v15, v140, v141, v15
    v_max3_f32 v15, v142, v143, v15
    v_rcp_f32 v128, v128
    v_mfma_f32_32x32x16_bf16 v[224:239], a[180:183], v[240:243], v[224:239]
    v_rcp_f32 v129, v129
    v_rcp_f32 v130, v130
    v_rcp_f32 v131, v131
    v_mfma_f32_32x32x16_bf16 v[208:223], a[184:187], v[244:247], v[208:223]
    v_rcp_f32 v132, v132
    v_rcp_f32 v133, v133
    v_rcp_f32 v134, v134
    v_rcp_f32 v135, v135
    v_mfma_f32_32x32x16_bf16 v[224:239], a[188:191], v[244:247], v[224:239]
    v_rcp_f32 v136, v136
    v_rcp_f32 v137, v137
    v_rcp_f32 v138, v138
    v_mfma_f32_32x32x16_bf16 v[16:31], a[16:19], a[232:235], v[16:31]
    v_rcp_f32 v139, v139
    v_rcp_f32 v140, v140
    v_rcp_f32 v141, v141
    v_rcp_f32 v142, v142
    v_rcp_f32 v143, v143
    v_pk_mul_f32 v[64:65], v[64:65], v[128:129]
    v_pk_mul_f32 v[66:67], v[66:67], v[130:131]
    v_pk_mul_f32 v[68:69], v[68:69], v[132:133]
    v_pk_mul_f32 v[70:71], v[70:71], v[134:135]
    v_pk_mul_f32 v[72:73], v[72:73], v[136:137]
    v_pk_mul_f32 v[74:75], v[74:75], v[138:139]
    v_pk_mul_f32 v[76:77], v[76:77], v[140:141]
    v_pk_mul_f32 v[78:79], v[78:79], v[142:143]
    v_cvt_pk_bf16_f32 v248, v64, v65
    v_cvt_pk_bf16_f32 v249, v66, v67
    v_cvt_pk_bf16_f32 v250, v68, v69
    v_cvt_pk_bf16_f32 v251, v70, v71
    v_cvt_pk_bf16_f32 v252, v72, v73
    v_cvt_pk_bf16_f32 v253, v74, v75
    v_cvt_pk_bf16_f32 v254, v76, v77
    v_cvt_pk_bf16_f32 v255, v78, v79
    v_cmp_le_f32 s[46:47], s48, v15
    v_bfe_u32 v15, v14, 16, 2
    v_mfma_f32_32x32x16_bf16 v[208:223], a[192:195], v[248:251], v[208:223]
    v_exp_f32 v80, v16
    v_exp_f32 v81, v17
    v_exp_f32 v82, v18
    v_mfma_f32_32x32x16_bf16 v[224:239], a[196:199], v[248:251], v[224:239]
    s_or_b64 s[52:53], s[52:53], s[46:47]
    v_exp_f32 v83, v19
    v_exp_f32 v84, v20
    v_exp_f32 v85, v21
    v_mfma_f32_32x32x16_bf16 v[208:223], a[200:203], v[252:255], v[208:223]
    v_exp_f32 v86, v22
    v_exp_f32 v87, v23
    v_exp_f32 v88, v24
    v_mfma_f32_32x32x16_bf16 v[224:239], a[204:207], v[252:255], v[224:239]
    v_cmp_ne_u32 s[40:41], 0, v15
    v_mov_b32 v128, 0x207
    v_accvgpr_read_b32 v15, a238
    v_accvgpr_read_b32 v129, a241
    v_accvgpr_read_b32 v132, a242
    v_accvgpr_read_b32 v133, a243
    v_accvgpr_read_b32 v134, a244
    v_accvgpr_read_b32 v135, a245
    v_accvgpr_read_b32 v14, a236
    v_exp_f32 v89, v25
    v_exp_f32 v90, v26
    v_exp_f32 v91, v27
    v_exp_f32 v92, v28
    v_exp_f32 v93, v29
    v_exp_f32 v94, v30
    v_exp_f32_e64 v95, v31
    v_pk_mul_f32 v[208:209], v[208:209], s[44:45]
    v_pk_mul_f32 v[210:211], v[210:211], s[44:45]
    v_pk_mul_f32 v[212:213], v[212:213], s[44:45]
    v_pk_mul_f32 v[214:215], v[214:215], s[44:45]
    v_pk_mul_f32 v[216:217], v[216:217], s[44:45]
    v_pk_mul_f32 v[218:219], v[218:219], s[44:45]
    v_pk_mul_f32 v[220:221], v[220:221], s[44:45]
    v_pk_mul_f32 v[222:223], v[222:223], s[44:45]
    v_pk_mul_f32 v[224:225], v[224:225], s[44:45]
    v_pk_mul_f32 v[226:227], v[226:227], s[44:45]
    v_pk_mul_f32 v[228:229], v[228:229], s[44:45]
    v_pk_mul_f32 v[230:231], v[230:231], s[44:45]
    v_pk_mul_f32 v[232:233], v[232:233], s[44:45]
    v_pk_mul_f32 v[234:235], v[234:235], s[44:45]
    v_pk_mul_f32 v[236:237], v[236:237], s[44:45]
    v_pk_mul_f32 v[238:239], v[238:239], s[44:45]
    v_pk_add_f32 v[80:81], v[80:81], 1.0 op_sel_hi:[1,0]
    v_pk_add_f32 v[82:83], v[82:83], 1.0 op_sel_hi:[1,0]
    v_pk_add_f32 v[84:85], v[84:85], 1.0 op_sel_hi:[1,0]
    v_pk_add_f32 v[86:87], v[86:87], 1.0 op_sel_hi:[1,0]
    v_pk_add_f32 v[88:89], v[88:89], 1.0 op_sel_hi:[1,0]
    v_pk_add_f32 v[90:91], v[90:91], 1.0 op_sel_hi:[1,0]
    v_pk_add_f32 v[92:93], v[92:93], 1.0 op_sel_hi:[1,0]
    v_pk_add_f32 v[94:95], v[94:95], 1.0 op_sel_hi:[1,0]
    v_cmp_class_f32 s[46:47], v208, v128
    s_mov_b64 exec, s[40:41]
    v_mfma_f32_32x32x16_bf16 v[32:47], a[20:23], a[216:219], v[160:175]
    v_add_f32_dpp v208, v208, v208 quad_perm:[1,0,3,2] row_mask:0xf bank_mask:0xf
    v_add_f32_dpp v209, v209, v209 quad_perm:[1,0,3,2] row_mask:0xf bank_mask:0xf
    v_add_f32_dpp v210, v210, v210 quad_perm:[1,0,3,2] row_mask:0xf bank_mask:0xf
    v_add_f32_dpp v211, v211, v211 quad_perm:[1,0,3,2] row_mask:0xf bank_mask:0xf
    v_add_f32_dpp v212, v212, v212 quad_perm:[1,0,3,2] row_mask:0xf bank_mask:0xf
    v_add_f32_dpp v213, v213, v213 quad_perm:[1,0,3,2] row_mask:0xf bank_mask:0xf
    v_add_f32_dpp v214, v214, v214 quad_perm:[1,0,3,2] row_mask:0xf bank_mask:0xf
    v_mfma_f32_32x32x16_bf16 v[32:47], a[24:27], a[220:223], v[32:47]
    v_add_f32_dpp v215, v215, v215 quad_perm:[1,0,3,2] row_mask:0xf bank_mask:0xf
    v_add_f32_dpp v216, v216, v216 quad_perm:[1,0,3,2] row_mask:0xf bank_mask:0xf
    v_add_f32_dpp v217, v217, v217 quad_perm:[1,0,3,2] row_mask:0xf bank_mask:0xf
    v_add_f32_dpp v218, v218, v218 quad_perm:[1,0,3,2] row_mask:0xf bank_mask:0xf
    v_add_f32_dpp v219, v219, v219 quad_perm:[1,0,3,2] row_mask:0xf bank_mask:0xf
    v_add_f32_dpp v220, v220, v220 quad_perm:[1,0,3,2] row_mask:0xf bank_mask:0xf
    v_mfma_f32_32x32x16_bf16 v[32:47], a[28:31], a[224:227], v[32:47]
    v_add_f32_dpp v221, v221, v221 quad_perm:[1,0,3,2] row_mask:0xf bank_mask:0xf
    v_add_f32_dpp v222, v222, v222 quad_perm:[1,0,3,2] row_mask:0xf bank_mask:0xf
    v_add_f32_dpp v223, v223, v223 quad_perm:[1,0,3,2] row_mask:0xf bank_mask:0xf
    v_add_f32_dpp v224, v224, v224 quad_perm:[1,0,3,2] row_mask:0xf bank_mask:0xf
    v_add_f32_dpp v225, v225, v225 quad_perm:[1,0,3,2] row_mask:0xf bank_mask:0xf
    v_add_f32_dpp v226, v226, v226 quad_perm:[1,0,3,2] row_mask:0xf bank_mask:0xf
    v_add_f32_dpp v227, v227, v227 quad_perm:[1,0,3,2] row_mask:0xf bank_mask:0xf
    v_mfma_f32_32x32x16_bf16 v[32:47], a[32:35], a[228:231], v[32:47]
    v_add_f32_dpp v228, v228, v228 quad_perm:[1,0,3,2] row_mask:0xf bank_mask:0xf
    v_add_f32_dpp v229, v229, v229 quad_perm:[1,0,3,2] row_mask:0xf bank_mask:0xf
    v_add_f32_dpp v230, v230, v230 quad_perm:[1,0,3,2] row_mask:0xf bank_mask:0xf
    v_add_f32_dpp v231, v231, v231 quad_perm:[1,0,3,2] row_mask:0xf bank_mask:0xf
    v_add_f32_dpp v232, v232, v232 quad_perm:[1,0,3,2] row_mask:0xf bank_mask:0xf
    v_add_f32_dpp v233, v233, v233 quad_perm:[1,0,3,2] row_mask:0xf bank_mask:0xf
    v_mfma_f32_32x32x16_bf16 v[32:47], a[36:39], a[232:235], v[32:47]
    v_add_f32_dpp v234, v234, v234 quad_perm:[1,0,3,2] row_mask:0xf bank_mask:0xf
    v_add_f32_dpp v235, v235, v235 quad_perm:[1,0,3,2] row_mask:0xf bank_mask:0xf
    v_add_f32_dpp v236, v236, v236 quad_perm:[1,0,3,2] row_mask:0xf bank_mask:0xf
    v_add_f32_dpp v237, v237, v237 quad_perm:[1,0,3,2] row_mask:0xf bank_mask:0xf
    v_add_f32_dpp v238, v238, v238 quad_perm:[1,0,3,2] row_mask:0xf bank_mask:0xf
    v_add_f32_dpp v239, v239, v239 quad_perm:[1,0,3,2] row_mask:0xf bank_mask:0xf
    s_mov_b64 exec, -1
    s_or_b64 s[52:53], s[52:53], s[46:47]
    v_cvt_pk_bf16_f32 v240, v208, v209
    v_cvt_pk_bf16_f32 v241, v210, v211
    v_cvt_pk_bf16_f32 v242, v212, v213
    v_cvt_pk_bf16_f32 v243, v214, v215
    v_cvt_pk_bf16_f32 v244, v216, v217
    v_cvt_pk_bf16_f32 v245, v218, v219
    v_cvt_pk_bf16_f32 v246, v220, v221
    v_cvt_pk_bf16_f32 v247, v222, v223
    v_cvt_pk_bf16_f32 v248, v224, v225
    v_cvt_pk_bf16_f32 v249, v226, v227
    v_cvt_pk_bf16_f32 v250, v228, v229
    v_cvt_pk_bf16_f32 v251, v230, v231
    v_cvt_pk_bf16_f32 v252, v232, v233
    v_cvt_pk_bf16_f32 v253, v234, v235
    v_cvt_pk_bf16_f32 v254, v236, v237
    v_cvt_pk_bf16_f32 v255, v238, v239
    v_mfma_f32_32x32x16_bf16 v[48:63], a[40:43], a[216:219], v[176:191]
    ds_write_b128 v15, v[240:243] offset:0
    ds_write_b128 v15, v[244:247] offset:16
    v_exp_f32 v96, v32
    v_exp_f32 v97, v33
    v_exp_f32 v98, v34
    v_mfma_f32_32x32x16_bf16 v[48:63], a[44:47], a[220:223], v[48:63]
    ds_write_b128 v15, v[248:251] offset:32
    ds_write_b128 v15, v[252:255] offset:48
    v_exp_f32 v99, v35
    v_exp_f32 v100, v36
    v_exp_f32 v101, v37
    v_mfma_f32_32x32x16_bf16 v[48:63], a[48:51], a[224:227], v[48:63]
    ds_read_b128 v[224:227], v129 offset:0
    ds_read_b128 v[228:231], v129 offset:1152
    v_exp_f32 v102, v38
    v_exp_f32 v103, v39
    v_exp_f32 v104, v40
    v_mfma_f32_32x32x16_bf16 v[48:63], a[52:55], a[228:231], v[48:63]
    ds_read_b128 v[232:235], v129 offset:2304
    ds_read_b128 v[236:239], v129 offset:3456
    v_exp_f32 v105, v41
    v_exp_f32 v106, v42
    v_exp_f32 v107, v43
    v_mfma_f32_32x32x16_bf16 v[48:63], a[56:59], a[232:235], v[48:63]
    v_exp_f32 v108, v44
    v_exp_f32 v109, v45
    v_exp_f32 v110, v46
    v_exp_f32_e64 v111, v47
    v_pk_add_f32 v[96:97], v[96:97], 1.0 op_sel_hi:[1,0]
    v_pk_add_f32 v[98:99], v[98:99], 1.0 op_sel_hi:[1,0]
    v_pk_add_f32 v[100:101], v[100:101], 1.0 op_sel_hi:[1,0]
    v_pk_add_f32 v[102:103], v[102:103], 1.0 op_sel_hi:[1,0]
    v_pk_add_f32 v[104:105], v[104:105], 1.0 op_sel_hi:[1,0]
    v_pk_add_f32 v[106:107], v[106:107], 1.0 op_sel_hi:[1,0]
    v_pk_add_f32 v[108:109], v[108:109], 1.0 op_sel_hi:[1,0]
    v_pk_add_f32 v[110:111], v[110:111], 1.0 op_sel_hi:[1,0]
    v_mfma_f32_32x32x16_bf16 v[64:79], a[60:63], a[216:219], v[192:207]
    s_waitcnt vmcnt(5) lgkmcnt(0)
    ds_read_b128 a[216:219], v12 offset:5248
    buffer_store_dwordx4 v[224:227], v132, s[16:19], 0 offen sc1
    buffer_store_dwordx4 v[228:231], v133, s[16:19], 0 offen sc1
    v_exp_f32 v112, v48
    v_exp_f32 v113, v49
    v_exp_f32 v114, v50
    v_mfma_f32_32x32x16_bf16 v[64:79], a[64:67], a[220:223], v[64:79]
    ds_read_b128 a[220:223], v12 offset:5280
    buffer_store_dwordx4 v[232:235], v134, s[16:19], 0 offen sc1
    buffer_store_dwordx4 v[236:239], v135, s[16:19], 0 offen sc1
    v_exp_f32 v115, v51
    v_exp_f32 v116, v52
    v_exp_f32 v117, v53
    v_mfma_f32_32x32x16_bf16 v[64:79], a[68:71], a[224:227], v[64:79]
    ds_read_b128 a[224:227], v12 offset:5312
    v_exp_f32 v118, v54
    v_exp_f32 v119, v55
    v_exp_f32 v120, v56
    v_mfma_f32_32x32x16_bf16 v[64:79], a[72:75], a[228:231], v[64:79]
    ds_read_b128 a[228:231], v12 offset:5344
    v_exp_f32 v121, v57
    v_exp_f32 v122, v58
    v_exp_f32 v123, v59
    v_mfma_f32_32x32x16_bf16 v[64:79], a[76:79], a[232:235], v[64:79]
    s_waitcnt lgkmcnt(2)
    ds_read_b128 a[232:235], v13 offset:9472
    v_exp_f32 v124, v60
    v_exp_f32 v125, v61
    v_exp_f32 v126, v62
    v_exp_f32 v127, v63
    v_pk_add_f32 v[112:113], v[112:113], 1.0 op_sel_hi:[1,0]
    v_pk_add_f32 v[114:115], v[114:115], 1.0 op_sel_hi:[1,0]
    v_pk_add_f32 v[116:117], v[116:117], 1.0 op_sel_hi:[1,0]
    v_pk_add_f32 v[118:119], v[118:119], 1.0 op_sel_hi:[1,0]
    v_pk_add_f32 v[120:121], v[120:121], 1.0 op_sel_hi:[1,0]
    v_pk_add_f32 v[122:123], v[122:123], 1.0 op_sel_hi:[1,0]
    v_pk_add_f32 v[124:125], v[124:125], 1.0 op_sel_hi:[1,0]
    v_pk_add_f32 v[126:127], v[126:127], 1.0 op_sel_hi:[1,0]
    v_mfma_f32_32x32x16_bf16 v[208:223], a[0:3], a[216:219], v[144:159]
    v_exp_f32 v128, v64
    v_exp_f32 v129, v65
    v_exp_f32 v130, v66
    v_mfma_f32_32x32x16_bf16 v[208:223], a[4:7], a[220:223], v[208:223]
    s_waitcnt lgkmcnt(0)
    v_exp_f32 v131, v67
    v_exp_f32 v132, v68
    v_exp_f32 v133, v69
    v_mfma_f32_32x32x16_bf16 v[208:223], a[8:11], a[224:227], v[208:223]
    s_mov_b32 s38, 0x01000000
    v_exp_f32 v134, v70
    v_exp_f32 v135, v71
    v_exp_f32 v136, v72
    v_mfma_f32_32x32x16_bf16 v[208:223], a[12:15], a[228:231], v[208:223]
    s_cmp_eq_u32 s38, s39
    v_exp_f32 v137, v73
    v_exp_f32 v138, v74
    v_exp_f32 v139, v75
    v_mfma_f32_32x32x16_bf16 v[208:223], a[16:19], a[232:235], v[208:223]
    v_cmp_gt_u32 vcc, s38, v14
    v_exp_f32 v140, v76
    v_exp_f32 v141, v77
    v_exp_f32 v142, v78
    v_exp_f32_e64 v143, v79
    v_pk_add_f32 v[128:129], v[128:129], 1.0 op_sel_hi:[1,0]
    v_pk_add_f32 v[130:131], v[130:131], 1.0 op_sel_hi:[1,0]
    v_pk_add_f32 v[132:133], v[132:133], 1.0 op_sel_hi:[1,0]
    v_pk_add_f32 v[134:135], v[134:135], 1.0 op_sel_hi:[1,0]
    v_pk_add_f32 v[136:137], v[136:137], 1.0 op_sel_hi:[1,0]
    v_pk_add_f32 v[138:139], v[138:139], 1.0 op_sel_hi:[1,0]
    v_pk_add_f32 v[140:141], v[140:141], 1.0 op_sel_hi:[1,0]
    v_pk_add_f32 v[142:143], v[142:143], 1.0 op_sel_hi:[1,0]
    s_cbranch_vccnz k2_fix0
k2_fix0_back:
    s_cbranch_scc1 k2_fin
    s_cmp_ge_i32 s38, s50
    v_mfma_f32_32x32x16_bf16 v[224:239], a[20:23], a[216:219], v[160:175]
    s_cbranch_scc1 k2_e11
k2_u01:
    ds_read_u16 v2, v1 offset:768
    v_exp_f32 v240, v208
    v_exp_f32 v241, v209
    v_exp_f32 v242, v210
    v_mfma_f32_32x32x16_bf16 v[224:239], a[24:27], a[220:223], v[224:239]
    ds_read_u16 v4, v1 offset:800
    v_exp_f32 v243, v211
    v_exp_f32 v244, v212
    v_exp_f32 v245, v213
    v_mfma_f32_32x32x16_bf16 v[224:239], a[28:31], a[224:227], v[224:239]
    ds_read_u16 v6, v1 offset:832
    v_exp_f32 v246, v214
    v_exp_f32 v247, v215
    v_exp_f32 v248, v216
    v_mfma_f32_32x32x16_bf16 v[224:239], a[32:35], a[228:231], v[224:239]
    ds_read_u16 v8, v1 offset:864
    v_exp_f32 v249, v217
    v_exp_f32 v250, v218
    v_exp_f32 v251, v219
    v_mfma_f32_32x32x16_bf16 v[224:239], a[36:39], a[232:235], v[224:239]
    ds_read_b32 v10, v0 offset:772
    v_exp_f32 v252, v220
    v_exp_f32 v253, v221
    v_exp_f32 v254, v222
    v_exp_f32 v255, v223
    v_pk_fma_f32 v[16:17], v[16:17], v[240:241], v[16:17]
    v_pk_fma_f32 v[18:19], v[18:19], v[242:243], v[18:19]
    v_pk_fma_f32 v[20:21], v[20:21], v[244:245], v[20:21]
    v_pk_fma_f32 v[22:23], v[22:23], v[246:247], v[22:23]
    v_pk_fma_f32 v[24:25], v[24:25], v[248:249], v[24:25]
    v_pk_fma_f32 v[26:27], v[26:27], v[250:251], v[26:27]
    v_pk_fma_f32 v[28:29], v[28:29], v[252:253], v[28:29]
    v_pk_fma_f32 v[30:31], v[30:31], v[254:255], v[30:31]
    v_pk_fma_f32 v[16:17], v[208:209], v[80:81], v[16:17]
    v_pk_fma_f32 v[18:19], v[210:211], v[82:83], v[18:19]
    v_pk_fma_f32 v[20:21], v[212:213], v[84:85], v[20:21]
    v_pk_fma_f32 v[22:23], v[214:215], v[86:87], v[22:23]
    v_pk_fma_f32 v[24:25], v[216:217], v[88:89], v[24:25]
    v_pk_fma_f32 v[26:27], v[218:219], v[90:91], v[26:27]
    v_pk_fma_f32 v[28:29], v[220:221], v[92:93], v[28:29]
    v_pk_fma_f32 v[30:31], v[222:223], v[94:95], v[30:31]
    v_pk_fma_f32 v[80:81], v[80:81], v[240:241], v[80:81]
    v_pk_fma_f32 v[82:83], v[82:83], v[242:243], v[82:83]
    v_pk_fma_f32 v[84:85], v[84:85], v[244:245], v[84:85]
    v_pk_fma_f32 v[86:87], v[86:87], v[246:247], v[86:87]
    v_pk_fma_f32 v[88:89], v[88:89], v[248:249], v[88:89]
    v_pk_fma_f32 v[90:91], v[90:91], v[250:251], v[90:91]
    v_pk_fma_f32 v[92:93], v[92:93], v[252:253], v[92:93]
    v_pk_fma_f32 v[94:95], v[94:95], v[254:255], v[94:95]
    v_mfma_f32_32x32x16_bf16 v[208:223], a[40:43], a[216:219], v[176:191]
    s_waitcnt lgkmcnt(0)
    buffer_load_dwordx4 v[2:3], s[8:11], s33 idxen offen offset:0 lds
    buffer_load_dwordx4 v[4:5], s[8:11], s34 idxen offen offset:1056 lds
    v_exp_f32 v240, v224
    v_exp_f32 v241, v225
    v_exp_f32 v242, v226
    v_mfma_f32_32x32x16_bf16 v[208:223], a[44:47], a[220:223], v[208:223]
    buffer_load_dwordx4 v[6:7], s[8:11], s35 idxen offen offset:2112 lds
    v_exp_f32 v243, v227
    v_exp_f32 v244, v228
    v_exp_f32 v245, v229
    v_mfma_f32_32x32x16_bf16 v[208:223], a[48:51], a[224:227], v[208:223]
    buffer_load_dwordx4 v[8:9], s[8:11], 0 idxen offen offset:3168 lds
    v_exp_f32 v246, v230
    v_exp_f32 v247, v231
    v_exp_f32 v248, v232
    v_mfma_f32_32x32x16_bf16 v[208:223], a[52:55], a[228:231], v[208:223]
    s_mov_b32 m0, s67
    v_exp_f32 v249, v233
    v_exp_f32 v250, v234
    v_exp_f32 v251, v235
    v_mfma_f32_32x32x16_bf16 v[208:223], a[56:59], a[232:235], v[208:223]
    buffer_load_dwordx4 v[10:11], s[12:15], 0 idxen offen lds
    v_exp_f32 v252, v236
    v_exp_f32 v253, v237
    v_exp_f32 v254, v238
    v_exp_f32 v255, v239
    v_pk_fma_f32 v[32:33], v[32:33], v[240:241], v[32:33]
    v_pk_fma_f32 v[34:35], v[34:35], v[242:243], v[34:35]
    v_pk_fma_f32 v[36:37], v[36:37], v[244:245], v[36:37]
    v_pk_fma_f32 v[38:39], v[38:39], v[246:247], v[38:39]
    v_pk_fma_f32 v[40:41], v[40:41], v[248:249], v[40:41]
    v_pk_fma_f32 v[42:43], v[42:43], v[250:251], v[42:43]
    v_pk_fma_f32 v[44:45], v[44:45], v[252:253], v[44:45]
    v_pk_fma_f32 v[46:47], v[46:47], v[254:255], v[46:47]
    v_pk_fma_f32 v[32:33], v[224:225], v[96:97], v[32:33]
    v_pk_fma_f32 v[34:35], v[226:227], v[98:99], v[34:35]
    v_pk_fma_f32 v[36:37], v[228:229], v[100:101], v[36:37]
    v_pk_fma_f32 v[38:39], v[230:231], v[102:103], v[38:39]
    v_pk_fma_f32 v[40:41], v[232:233], v[104:105], v[40:41]
    v_pk_fma_f32 v[42:43], v[234:235], v[106:107], v[42:43]
    v_pk_fma_f32 v[44:45], v[236:237], v[108:109], v[44:45]
    v_pk_fma_f32 v[46:47], v[238:239], v[110:111], v[46:47]
    v_pk_fma_f32 v[96:97], v[96:97], v[240:241], v[96:97]
    v_pk_fma_f32 v[98:99], v[98:99], v[242:243], v[98:99]
    v_pk_fma_f32 v[100:101], v[100:101], v[244:245], v[100:101]
    v_pk_fma_f32 v[102:103], v[102:103], v[246:247], v[102:103]
    v_pk_fma_f32 v[104:105], v[104:105], v[248:249], v[104:105]
    v_pk_fma_f32 v[106:107], v[106:107], v[250:251], v[106:107]
    v_pk_fma_f32 v[108:109], v[108:109], v[252:253], v[108:109]
    v_pk_fma_f32 v[110:111], v[110:111], v[254:255], v[110:111]
    v_mfma_f32_32x32x16_bf16 v[224:239], a[60:63], a[216:219], v[192:207]
    s_waitcnt vmcnt(5)
    ds_read_b128 a[216:219], v12 offset:0
    v_exp_f32 v240, v208
    v_exp_f32 v241, v209
    v_exp_f32 v242, v210
    v_mfma_f32_32x32x16_bf16 v[224:239], a[64:67], a[220:223], v[224:239]
    s_mov_b32 m0, s36
    ds_read_b128 a[220:223], v12 offset:32
    v_exp_f32 v243, v211
    v_exp_f32 v244, v212
    v_exp_f32 v245, v213
    v_mfma_f32_32x32x16_bf16 v[224:239], a[68:71], a[224:227], v[224:239]
    ds_read_b128 a[224:227], v12 offset:64
    v_exp_f32 v246, v214
    v_exp_f32 v247, v215
    v_exp_f32 v248, v216
    v_mfma_f32_32x32x16_bf16 v[224:239], a[72:75], a[228:231], v[224:239]
    ds_read_b128 a[228:231], v12 offset:96
    v_exp_f32 v249, v217
    v_exp_f32 v250, v218
    v_exp_f32 v251, v219
    v_mfma_f32_32x32x16_bf16 v[224:239], a[76:79], a[232:235], v[224:239]
    s_waitcnt lgkmcnt(2)
    ds_read_b128 a[232:235], v13 offset:4224
    v_exp_f32 v252, v220
    v_exp_f32 v253, v221
    v_exp_f32 v254, v222
    v_exp_f32_e64 v255, v223
    v_pk_fma_f32 v[48:49], v[48:49], v[240:241], v[48:49]
    v_pk_fma_f32 v[50:51], v[50:51], v[242:243], v[50:51]
    v_pk_fma_f32 v[52:53], v[52:53], v[244:245], v[52:53]
    v_pk_fma_f32 v[54:55], v[54:55], v[246:247], v[54:55]
    v_pk_fma_f32 v[56:57], v[56:57], v[248:249], v[56:57]
    v_pk_fma_f32 v[58:59], v[58:59], v[250:251], v[58:59]
    v_pk_fma_f32 v[60:61], v[60:61], v[252:253], v[60:61]
    v_pk_fma_f32 v[62:63], v[62:63], v[254:255], v[62:63]
    v_pk_fma_f32 v[48:49], v[208:209], v[112:113], v[48:49]
    v_pk_fma_f32 v[50:51], v[210:211], v[114:115], v[50:51]
    v_pk_fma_f32 v[52:53], v[212:213], v[116:117], v[52:53]
    v_pk_fma_f32 v[54:55], v[214:215], v[118:119], v[54:55]
    v_pk_fma_f32 v[56:57], v[216:217], v[120:121], v[56:57]
    v_pk_fma_f32 v[58:59], v[218:219], v[122:123], v[58:59]
    v_pk_fma_f32 v[60:61], v[220:221], v[124:125], v[60:61]
    v_pk_fma_f32 v[62:63], v[222:223], v[126:127], v[62:63]
    v_pk_fma_f32 v[112:113], v[112:113], v[240:241], v[112:113]
    v_pk_fma_f32 v[114:115], v[114:115], v[242:243], v[114:115]
    v_pk_fma_f32 v[116:117], v[116:117], v[244:245], v[116:117]
    v_pk_fma_f32 v[118:119], v[118:119], v[246:247], v[118:119]
    v_pk_fma_f32 v[120:121], v[120:121], v[248:249], v[120:121]
    v_pk_fma_f32 v[122:123], v[122:123], v[250:251], v[122:123]
    v_pk_fma_f32 v[124:125], v[124:125], v[252:253], v[124:125]
    v_pk_fma_f32 v[126:127], v[126:127], v[254:255], v[126:127]
    v_mfma_f32_32x32x16_bf16 v[208:223], a[0:3], a[216:219], v[144:159]
    v_exp_f32 v240, v224
    v_exp_f32 v241, v225
    v_exp_f32 v242, v226
    v_mfma_f32_32x32x16_bf16 v[208:223], a[4:7], a[220:223], v[208:223]
    s_waitcnt lgkmcnt(0)
    v_exp_f32 v243, v227
    v_exp_f32 v244, v228
    v_exp_f32 v245, v229
    v_mfma_f32_32x32x16_bf16 v[208:223], a[8:11], a[224:227], v[208:223]
    s_add_u32 s38, s38, 0x01000000
    v_exp_f32 v246, v230
    v_exp_f32 v247, v231
    v_exp_f32 v248, v232
    v_mfma_f32_32x32x16_bf16 v[208:223], a[12:15], a[228:231], v[208:223]
    s_cmp_ge_i32 s38, s50
    v_add_u32 v1, 512, v1
    v_exp_f32 v249, v233
    v_exp_f32 v250, v234
    v_exp_f32 v251, v235
    v_mfma_f32_32x32x16_bf16 v[208:223], a[16:19], a[232:235], v[208:223]
    v_add_u32 v0, 512, v0
    v_exp_f32 v252, v236
    v_exp_f32 v253, v237
    v_exp_f32 v254, v238
    v_exp_f32 v255, v239
    v_pk_fma_f32 v[64:65], v[64:65], v[240:241], v[64:65]
    v_pk_fma_f32 v[66:67], v[66:67], v[242:243], v[66:67]
    v_pk_fma_f32 v[68:69], v[68:69], v[244:245], v[68:69]
    v_pk_fma_f32 v[70:71], v[70:71], v[246:247], v[70:71]
    v_pk_fma_f32 v[72:73], v[72:73], v[248:249], v[72:73]
    v_pk_fma_f32 v[74:75], v[74:75], v[250:251], v[74:75]
    v_pk_fma_f32 v[76:77], v[76:77], v[252:253], v[76:77]
    v_pk_fma_f32 v[78:79], v[78:79], v[254:255], v[78:79]
    v_pk_fma_f32 v[64:65], v[224:225], v[128:129], v[64:65]
    v_pk_fma_f32 v[66:67], v[226:227], v[130:131], v[66:67]
    v_pk_fma_f32 v[68:69], v[228:229], v[132:133], v[68:69]
    v_pk_fma_f32 v[70:71], v[230:231], v[134:135], v[70:71]
    v_pk_fma_f32 v[72:73], v[232:233], v[136:137], v[72:73]
    v_pk_fma_f32 v[74:75], v[234:235], v[138:139], v[74:75]
    v_pk_fma_f32 v[76:77], v[236:237], v[140:141], v[76:77]
    v_pk_fma_f32 v[78:79], v[238:239], v[142:143], v[78:79]
    v_pk_fma_f32 v[128:129], v[128:129], v[240:241], v[128:129]
    v_pk_fma_f32 v[130:131], v[130:131], v[242:243], v[130:131]
    v_pk_fma_f32 v[132:133], v[132:133], v[244:245], v[132:133]
    v_pk_fma_f32 v[134:135], v[134:135], v[246:247], v[134:135]
    v_pk_fma_f32 v[136:137], v[136:137], v[248:249], v[136:137]
    v_pk_fma_f32 v[138:139], v[138:139], v[250:251], v[138:139]
    v_pk_fma_f32 v[140:141], v[140:141], v[252:253], v[140:141]
    v_pk_fma_f32 v[142:143], v[142:143], v[254:255], v[142:143]
    v_mfma_f32_32x32x16_bf16 v[224:239], a[20:23], a[216:219], v[160:175]
    s_cbranch_scc1 k2_e10
    ds_read_u16 v2, v1 offset:512
    v_exp_f32 v240, v208
    v_exp_f32 v241, v209
    v_exp_f32 v242, v210
    v_mfma_f32_32x32x16_bf16 v[224:239], a[24:27], a[220:223], v[224:239]
    ds_read_u16 v4, v1 offset:544
    v_exp_f32 v243, v211
    v_exp_f32 v244, v212
    v_exp_f32 v245, v213
    v_mfma_f32_32x32x16_bf16 v[224:239], a[28:31], a[224:227], v[224:239]
    ds_read_u16 v6, v1 offset:576
    v_exp_f32 v246, v214
    v_exp_f32 v247, v215
    v_exp_f32 v248, v216
    v_mfma_f32_32x32x16_bf16 v[224:239], a[32:35], a[228:231], v[224:239]
    ds_read_u16 v8, v1 offset:608
    v_exp_f32 v249, v217
    v_exp_f32 v250, v218
    v_exp_f32 v251, v219
    v_mfma_f32_32x32x16_bf16 v[224:239], a[36:39], a[232:235], v[224:239]
    ds_read_b32 v10, v0 offset:516
    v_exp_f32 v252, v220
    v_exp_f32 v253, v221
    v_exp_f32 v254, v222
    v_exp_f32_e64 v255, v223
    v_pk_fma_f32 v[16:17], v[16:17], v[240:241], v[16:17]
    v_pk_fma_f32 v[18:19], v[18:19], v[242:243], v[18:19]
    v_pk_fma_f32 v[20:21], v[20:21], v[244:245], v[20:21]
    v_pk_fma_f32 v[22:23], v[22:23], v[246:247], v[22:23]
    v_pk_fma_f32 v[24:25], v[24:25], v[248:249], v[24:25]
    v_pk_fma_f32 v[26:27], v[26:27], v[250:251], v[26:27]
    v_pk_fma_f32 v[28:29], v[28:29], v[252:253], v[28:29]
    v_pk_fma_f32 v[30:31], v[30:31], v[254:255], v[30:31]
    v_pk_fma_f32 v[16:17], v[208:209], v[80:81], v[16:17]
    v_pk_fma_f32 v[18:19], v[210:211], v[82:83], v[18:19]
    v_pk_fma_f32 v[20:21], v[212:213], v[84:85], v[20:21]
    v_pk_fma_f32 v[22:23], v[214:215], v[86:87], v[22:23]
    v_pk_fma_f32 v[24:25], v[216:217], v[88:89], v[24:25]
    v_pk_fma_f32 v[26:27], v[218:219], v[90:91], v[26:27]
    v_pk_fma_f32 v[28:29], v[220:221], v[92:93], v[28:29]
    v_pk_fma_f32 v[30:31], v[222:223], v[94:95], v[30:31]
    v_pk_fma_f32 v[80:81], v[80:81], v[240:241], v[80:81]
    v_pk_fma_f32 v[82:83], v[82:83], v[242:243], v[82:83]
    v_pk_fma_f32 v[84:85], v[84:85], v[244:245], v[84:85]
    v_pk_fma_f32 v[86:87], v[86:87], v[246:247], v[86:87]
    v_pk_fma_f32 v[88:89], v[88:89], v[248:249], v[88:89]
    v_pk_fma_f32 v[90:91], v[90:91], v[250:251], v[90:91]
    v_pk_fma_f32 v[92:93], v[92:93], v[252:253], v[92:93]
    v_pk_fma_f32 v[94:95], v[94:95], v[254:255], v[94:95]
    v_mfma_f32_32x32x16_bf16 v[208:223], a[40:43], a[216:219], v[176:191]
    s_waitcnt lgkmcnt(0)
    buffer_load_dwordx4 v[2:3], s[8:11], s33 idxen offen offset:0 lds
    buffer_load_dwordx4 v[4:5], s[8:11], s34 idxen offen offset:1056 lds
    v_exp_f32 v240, v224
    v_exp_f32 v241, v225
    v_exp_f32 v242, v226
    v_mfma_f32_32x32x16_bf16 v[208:223], a[44:47], a[220:223], v[208:223]
    buffer_load_dwordx4 v[6:7], s[8:11], s35 idxen offen offset:2112 lds
    v_exp_f32 v243, v227
    v_exp_f32 v244, v228
    v_exp_f32 v245, v229
    v_mfma_f32_32x32x16_bf16 v[208:223], a[48:51], a[224:227], v[208:223]
    buffer_load_dwordx4 v[8:9], s[8:11], 0 idxen offen offset:3168 lds
    v_exp_f32 v246, v230
    v_exp_f32 v247, v231
    v_exp_f32 v248, v232
    v_mfma_f32_32x32x16_bf16 v[208:223], a[52:55], a[228:231], v[208:223]
    s_mov_b32 m0, s66
    v_exp_f32 v249, v233
    v_exp_f32 v250, v234
    v_exp_f32 v251, v235
    v_mfma_f32_32x32x16_bf16 v[208:223], a[56:59], a[232:235], v[208:223]
    buffer_load_dwordx4 v[10:11], s[12:15], 0 idxen offen lds
    v_exp_f32 v252, v236
    v_exp_f32 v253, v237
    v_exp_f32 v254, v238
    v_exp_f32 v255, v239
    v_pk_fma_f32 v[32:33], v[32:33], v[240:241], v[32:33]
    v_pk_fma_f32 v[34:35], v[34:35], v[242:243], v[34:35]
    v_pk_fma_f32 v[36:37], v[36:37], v[244:245], v[36:37]
    v_pk_fma_f32 v[38:39], v[38:39], v[246:247], v[38:39]
    v_pk_fma_f32 v[40:41], v[40:41], v[248:249], v[40:41]
    v_pk_fma_f32 v[42:43], v[42:43], v[250:251], v[42:43]
    v_pk_fma_f32 v[44:45], v[44:45], v[252:253], v[44:45]
    v_pk_fma_f32 v[46:47], v[46:47], v[254:255], v[46:47]
    v_pk_fma_f32 v[32:33], v[224:225], v[96:97], v[32:33]
    v_pk_fma_f32 v[34:35], v[226:227], v[98:99], v[34:35]
    v_pk_fma_f32 v[36:37], v[228:229], v[100:101], v[36:37]
    v_pk_fma_f32 v[38:39], v[230:231], v[102:103], v[38:39]
    v_pk_fma_f32 v[40:41], v[232:233], v[104:105], v[40:41]
    v_pk_fma_f32 v[42:43], v[234:235], v[106:107], v[42:43]
    v_pk_fma_f32 v[44:45], v[236:237], v[108:109], v[44:45]
    v_pk_fma_f32 v[46:47], v[238:239], v[110:111], v[46:47]
    v_pk_fma_f32 v[96:97], v[96:97], v[240:241], v[96:97]
    v_pk_fma_f32 v[98:99], v[98:99], v[242:243], v[98:99]
    v_pk_fma_f32 v[100:101], v[100:101], v[244:245], v[100:101]
    v_pk_fma_f32 v[102:103], v[102:103], v[246:247], v[102:103]
    v_pk_fma_f32 v[104:105], v[104:105], v[248:249], v[104:105]
    v_pk_fma_f32 v[106:107], v[106:107], v[250:251], v[106:107]
    v_pk_fma_f32 v[108:109], v[108:109], v[252:253], v[108:109]
    v_pk_fma_f32 v[110:111], v[110:111], v[254:255], v[110:111]
    v_mfma_f32_32x32x16_bf16 v[224:239], a[60:63], a[216:219], v[192:207]
    s_waitcnt vmcnt(5)
    ds_read_b128 a[216:219], v12 offset:5248
    v_exp_f32 v240, v208
    v_exp_f32 v241, v209
    v_exp_f32 v242, v210
    v_mfma_f32_32x32x16_bf16 v[224:239], a[64:67], a[220:223], v[224:239]
    s_mov_b32 m0, s65
    ds_read_b128 a[220:223], v12 offset:5280
    v_exp_f32 v243, v211
    v_exp_f32 v244, v212
    v_exp_f32 v245, v213
    v_mfma_f32_32x32x16_bf16 v[224:239], a[68:71], a[224:227], v[224:239]
    ds_read_b128 a[224:227], v12 offset:5312
    v_exp_f32 v246, v214
    v_exp_f32 v247, v215
    v_exp_f32 v248, v216
    v_mfma_f32_32x32x16_bf16 v[224:239], a[72:75], a[228:231], v[224:239]
    ds_read_b128 a[228:231], v12 offset:5344
    v_exp_f32 v249, v217
    v_exp_f32 v250, v218
    v_exp_f32 v251, v219
    v_mfma_f32_32x32x16_bf16 v[224:239], a[76:79], a[232:235], v[224:239]
    s_waitcnt lgkmcnt(2)
    ds_read_b128 a[232:235], v13 offset:9472
    v_exp_f32 v252, v220
    v_exp_f32 v253, v221
    v_exp_f32 v254, v222
    v_exp_f32_e64 v255, v223
    v_pk_fma_f32 v[48:49], v[48:49], v[240:241], v[48:49]
    v_pk_fma_f32 v[50:51], v[50:51], v[242:243], v[50:51]
    v_pk_fma_f32 v[52:53], v[52:53], v[244:245], v[52:53]
    v_pk_fma_f32 v[54:55], v[54:55], v[246:247], v[54:55]
    v_pk_fma_f32 v[56:57], v[56:57], v[248:249], v[56:57]
    v_pk_fma_f32 v[58:59], v[58:59], v[250:251], v[58:59]
    v_pk_fma_f32 v[60:61], v[60:61], v[252:253], v[60:61]
    v_pk_fma_f32 v[62:63], v[62:63], v[254:255], v[62:63]
    v_pk_fma_f32 v[48:49], v[208:209], v[112:113], v[48:49]
    v_pk_fma_f32 v[50:51], v[210:211], v[114:115], v[50:51]
    v_pk_fma_f32 v[52:53], v[212:213], v[116:117], v[52:53]
    v_pk_fma_f32 v[54:55], v[214:215], v[118:119], v[54:55]
    v_pk_fma_f32 v[56:57], v[216:217], v[120:121], v[56:57]
    v_pk_fma_f32 v[58:59], v[218:219], v[122:123], v[58:59]
    v_pk_fma_f32 v[60:61], v[220:221], v[124:125], v[60:61]
    v_pk_fma_f32 v[62:63], v[222:223], v[126:127], v[62:63]
    v_pk_fma_f32 v[112:113], v[112:113], v[240:241], v[112:113]
    v_pk_fma_f32 v[114:115], v[114:115], v[242:243], v[114:115]
    v_pk_fma_f32 v[116:117], v[116:117], v[244:245], v[116:117]
    v_pk_fma_f32 v[118:119], v[118:119], v[246:247], v[118:119]
    v_pk_fma_f32 v[120:121], v[120:121], v[248:249], v[120:121]
    v_pk_fma_f32 v[122:123], v[122:123], v[250:251], v[122:123]
    v_pk_fma_f32 v[124:125], v[124:125], v[252:253], v[124:125]
    v_pk_fma_f32 v[126:127], v[126:127], v[254:255], v[126:127]
    v_mfma_f32_32x32x16_bf16 v[208:223], a[0:3], a[216:219], v[144:159]
    v_exp_f32 v240, v224
    v_exp_f32 v241, v225
    v_exp_f32 v242, v226
    v_mfma_f32_32x32x16_bf16 v[208:223], a[4:7], a[220:223], v[208:223]
    s_waitcnt lgkmcnt(0)
    v_exp_f32 v243, v227
    v_exp_f32 v244, v228
    v_exp_f32 v245, v229
    v_mfma_f32_32x32x16_bf16 v[208:223], a[8:11], a[224:227], v[208:223]
    s_add_u32 s38, s38, 0x01000000
    v_exp_f32 v246, v230
    v_exp_f32 v247, v231
    v_exp_f32 v248, v232
    v_mfma_f32_32x32x16_bf16 v[208:223], a[12:15], a[228:231], v[208:223]
    s_cmp_ge_i32 s38, s50
    v_exp_f32 v249, v233
    v_exp_f32 v250, v234
    v_exp_f32 v251, v235
    v_mfma_f32_32x32x16_bf16 v[208:223], a[16:19], a[232:235], v[208:223]
    v_exp_f32 v252, v236
    v_exp_f32 v253, v237
    v_exp_f32 v254, v238
    v_exp_f32 v255, v239
    v_pk_fma_f32 v[64:65], v[64:65], v[240:241], v[64:65]
    v_pk_fma_f32 v[66:67], v[66:67], v[242:243], v[66:67]
    v_pk_fma_f32 v[68:69], v[68:69], v[244:245], v[68:69]
    v_pk_fma_f32 v[70:71], v[70:71], v[246:247], v[70:71]
    v_pk_fma_f32 v[72:73], v[72:73], v[248:249], v[72:73]
    v_pk_fma_f32 v[74:75], v[74:75], v[250:251], v[74:75]
    v_pk_fma_f32 v[76:77], v[76:77], v[252:253], v[76:77]
    v_pk_fma_f32 v[78:79], v[78:79], v[254:255], v[78:79]
    v_pk_fma_f32 v[64:65], v[224:225], v[128:129], v[64:65]
    v_pk_fma_f32 v[66:67], v[226:227], v[130:131], v[66:67]
    v_pk_fma_f32 v[68:69], v[228:229], v[132:133], v[68:69]
    v_pk_fma_f32 v[70:71], v[230:231], v[134:135], v[70:71]
    v_pk_fma_f32 v[72:73], v[232:233], v[136:137], v[72:73]
    v_pk_fma_f32 v[74:75], v[234:235], v[138:139], v[74:75]
    v_pk_fma_f32 v[76:77], v[236:237], v[140:141], v[76:77]
    v_pk_fma_f32 v[78:79], v[238:239], v[142:143], v[78:79]
    v_pk_fma_f32 v[128:129], v[128:129], v[240:241], v[128:129]
    v_pk_fma_f32 v[130:131], v[130:131], v[242:243], v[130:131]
    v_pk_fma_f32 v[132:133], v[132:133], v[244:245], v[132:133]
    v_pk_fma_f32 v[134:135], v[134:135], v[246:247], v[134:135]
    v_pk_fma_f32 v[136:137], v[136:137], v[248:249], v[136:137]
    v_pk_fma_f32 v[138:139], v[138:139], v[250:251], v[138:139]
    v_pk_fma_f32 v[140:141], v[140:141], v[252:253], v[140:141]
    v_pk_fma_f32 v[142:143], v[142:143], v[254:255], v[142:143]
    v_mfma_f32_32x32x16_bf16 v[224:239], a[20:23], a[216:219], v[160:175]
    s_cbranch_scc0 k2_u01
k2_e11:
    s_cmp_ge_i32 s38, s51
    s_cbranch_scc1 k2_e21
k2_u11:
    v_exp_f32 v240, v208
    v_exp_f32 v241, v209
    v_exp_f32 v242, v210
    v_mfma_f32_32x32x16_bf16 v[224:239], a[24:27], a[220:223], v[224:239]
    v_exp_f32 v243, v211
    v_exp_f32 v244, v212
    v_exp_f32 v245, v213
    v_mfma_f32_32x32x16_bf16 v[224:239], a[28:31], a[224:227], v[224:239]
    ds_read_u16 v2, v1 offset:768
    v_exp_f32 v246, v214
    v_exp_f32 v247, v215
    v_exp_f32 v248, v216
    v_mfma_f32_32x32x16_bf16 v[224:239], a[32:35], a[228:231], v[224:239]
    ds_read_u16 v4, v1 offset:800
    v_exp_f32 v249, v217
    v_exp_f32 v250, v218
    v_exp_f32 v251, v219
    v_mfma_f32_32x32x16_bf16 v[224:239], a[36:39], a[232:235], v[224:239]
    ds_read_u16 v6, v1 offset:832
    v_exp_f32 v252, v220
    v_exp_f32 v253, v221
    v_exp_f32 v254, v222
    v_exp_f32_e64 v255, v223
    v_pk_fma_f32 v[16:17], v[16:17], v[240:241], v[16:17]
    v_pk_fma_f32 v[18:19], v[18:19], v[242:243], v[18:19]
    v_pk_fma_f32 v[20:21], v[20:21], v[244:245], v[20:21]
    v_pk_fma_f32 v[22:23], v[22:23], v[246:247], v[22:23]
    v_pk_fma_f32 v[24:25], v[24:25], v[248:249], v[24:25]
    v_pk_fma_f32 v[26:27], v[26:27], v[250:251], v[26:27]
    v_pk_fma_f32 v[28:29], v[28:29], v[252:253], v[28:29]
    v_pk_fma_f32 v[30:31], v[30:31], v[254:255], v[30:31]
    v_pk_fma_f32 v[16:17], v[208:209], v[80:81], v[16:17]
    v_pk_fma_f32 v[18:19], v[210:211], v[82:83], v[18:19]
    v_pk_fma_f32 v[20:21], v[212:213], v[84:85], v[20:21]
    v_pk_fma_f32 v[22:23], v[214:215], v[86:87], v[22:23]
    v_pk_fma_f32 v[24:25], v[216:217], v[88:89], v[24:25]
    v_pk_fma_f32 v[26:27], v[218:219], v[90:91], v[26:27]
    v_pk_fma_f32 v[28:29], v[220:221], v[92:93], v[28:29]
    v_pk_fma_f32 v[30:31], v[222:223], v[94:95], v[30:31]
    v_pk_fma_f32 v[80:81], v[80:81], v[240:241], v[80:81]
    v_pk_fma_f32 v[82:83], v[82:83], v[242:243], v[82:83]
    v_pk_fma_f32 v[84:85], v[84:85], v[244:245], v[84:85]
    v_pk_fma_f32 v[86:87], v[86:87], v[246:247], v[86:87]
    v_pk_fma_f32 v[88:89], v[88:89], v[248:249], v[88:89]
    v_pk_fma_f32 v[90:91], v[90:91], v[250:251], v[90:91]
    v_pk_fma_f32 v[92:93], v[92:93], v[252:253], v[92:93]
    v_pk_fma_f32 v[94:95], v[94:95], v[254:255], v[94:95]
    v_mfma_f32_32x32x16_bf16 v[208:223], a[40:43], a[216:219], v[176:191]
    v_exp_f32 v240, v224
    v_exp_f32 v241, v225
    v_exp_f32 v242, v226
    v_mfma_f32_32x32x16_bf16 v[208:223], a[44:47], a[220:223], v[208:223]
    v_exp_f32 v243, v227
    v_exp_f32 v244, v228
    v_exp_f32 v245, v229
    v_mfma_f32_32x32x16_bf16 v[208:223], a[48:51], a[224:227], v[208:223]
    v_exp_f32 v246, v230
    v_exp_f32 v247, v231
    v_exp_f32 v248, v232
    v_mfma_f32_32x32x16_bf16 v[208:223], a[52:55], a[228:231], v[208:223]
    ds_read_u16 v8, v1 offset:864
    v_exp_f32 v249, v233
    v_exp_f32 v250, v234
    v_exp_f32 v251, v235
    v_mfma_f32_32x32x16_bf16 v[208:223], a[56:59], a[232:235], v[208:223]
    ds_read_b32 v10, v0 offset:772
    v_exp_f32 v252, v236
    v_exp_f32 v253, v237
    v_exp_f32 v254, v238
    v_exp_f32 v255, v239
    v_pk_fma_f32 v[32:33], v[32:33], v[240:241], v[32:33]
    v_pk_fma_f32 v[34:35], v[34:35], v[242:243], v[34:35]
    v_pk_fma_f32 v[36:37], v[36:37], v[244:245], v[36:37]
    v_pk_fma_f32 v[38:39], v[38:39], v[246:247], v[38:39]
    v_pk_fma_f32 v[40:41], v[40:41], v[248:249], v[40:41]
    v_pk_fma_f32 v[42:43], v[42:43], v[250:251], v[42:43]
    v_pk_fma_f32 v[44:45], v[44:45], v[252:253], v[44:45]
    v_pk_fma_f32 v[46:47], v[46:47], v[254:255], v[46:47]
    v_pk_fma_f32 v[32:33], v[224:225], v[96:97], v[32:33]
    v_pk_fma_f32 v[34:35], v[226:227], v[98:99], v[34:35]
    v_pk_fma_f32 v[36:37], v[228:229], v[100:101], v[36:37]
    v_pk_fma_f32 v[38:39], v[230:231], v[102:103], v[38:39]
    v_pk_fma_f32 v[40:41], v[232:233], v[104:105], v[40:41]
    v_pk_fma_f32 v[42:43], v[234:235], v[106:107], v[42:43]
    v_pk_fma_f32 v[44:45], v[236:237], v[108:109], v[44:45]
    v_pk_fma_f32 v[46:47], v[238:239], v[110:111], v[46:47]
    v_pk_fma_f32 v[96:97], v[96:97], v[240:241], v[96:97]
    v_pk_fma_f32 v[98:99], v[98:99], v[242:243], v[98:99]
    v_pk_fma_f32 v[100:101], v[100:101], v[244:245], v[100:101]
    v_pk_fma_f32 v[102:103], v[102:103], v[246:247], v[102:103]
    v_pk_fma_f32 v[104:105], v[104:105], v[248:249], v[104:105]
    v_pk_fma_f32 v[106:107], v[106:107], v[250:251], v[106:107]
    v_pk_fma_f32 v[108:109], v[108:109], v[252:253], v[108:109]
    v_pk_fma_f32 v[110:111], v[110:111], v[254:255], v[110:111]
    v_mfma_f32_32x32x16_bf16 v[224:239], a[60:63], a[216:219], v[192:207]
    s_waitcnt vmcnt(1) lgkmcnt(0)
    ds_read_b128 a[216:219], v12 offset:0
    buffer_load_dwordx4 v[2:3], s[8:11], s33 idxen offen offset:0 lds
    v_exp_f32 v240, v208
    v_exp_f32 v241, v209
    v_exp_f32 v242, v210
    v_mfma_f32_32x32x16_bf16 v[224:239], a[64:67], a[220:223], v[224:239]
    ds_read_b128 a[220:223], v12 offset:32
    buffer_load_dwordx4 v[4:5], s[8:11], s34 idxen offen offset:1056 lds
    v_exp_f32 v243, v211
    v_exp_f32 v244, v212
    v_exp_f32 v245, v213
    v_mfma_f32_32x32x16_bf16 v[224:239], a[68:71], a[224:227], v[224:239]
    ds_read_b128 a[224:227], v12 offset:64
    buffer_load_dwordx4 v[6:7], s[8:11], s35 idxen offen offset:2112 lds
    buffer_load_dwordx4 v[8:9], s[8:11], 0 idxen offen offset:3168 lds
    v_exp_f32 v246, v214
    v_exp_f32 v247, v215
    v_exp_f32 v248, v216
    v_mfma_f32_32x32x16_bf16 v[224:239], a[72:75], a[228:231], v[224:239]
    s_mov_b32 m0, s67
    ds_read_b128 a[228:231], v12 offset:96
    v_exp_f32 v249, v217
    v_exp_f32 v250, v218
    v_exp_f32 v251, v219
    v_mfma_f32_32x32x16_bf16 v[224:239], a[76:79], a[232:235], v[224:239]
    s_waitcnt vmcnt(4) lgkmcnt(2)
    ds_read_b128 a[232:235], v13 offset:4224
    buffer_load_dwordx4 v[10:11], s[12:15], 0 idxen offen lds
    v_exp_f32 v252, v220
    v_exp_f32 v253, v221
    v_exp_f32 v254, v222
    v_exp_f32_e64 v255, v223
    v_pk_fma_f32 v[48:49], v[48:49], v[240:241], v[48:49]
    v_pk_fma_f32 v[50:51], v[50:51], v[242:243], v[50:51]
    v_pk_fma_f32 v[52:53], v[52:53], v[244:245], v[52:53]
    v_pk_fma_f32 v[54:55], v[54:55], v[246:247], v[54:55]
    v_pk_fma_f32 v[56:57], v[56:57], v[248:249], v[56:57]
    v_pk_fma_f32 v[58:59], v[58:59], v[250:251], v[58:59]
    v_pk_fma_f32 v[60:61], v[60:61], v[252:253], v[60:61]
    v_pk_fma_f32 v[62:63], v[62:63], v[254:255], v[62:63]
    v_pk_fma_f32 v[48:49], v[208:209], v[112:113], v[48:49]
    v_pk_fma_f32 v[50:51], v[210:211], v[114:115], v[50:51]
    v_pk_fma_f32 v[52:53], v[212:213], v[116:117], v[52:53]
    v_pk_fma_f32 v[54:55], v[214:215], v[118:119], v[54:55]
    v_pk_fma_f32 v[56:57], v[216:217], v[120:121], v[56:57]
    v_pk_fma_f32 v[58:59], v[218:219], v[122:123], v[58:59]
    v_pk_fma_f32 v[60:61], v[220:221], v[124:125], v[60:61]
    v_pk_fma_f32 v[62:63], v[222:223], v[126:127], v[62:63]
    v_pk_fma_f32 v[112:113], v[112:113], v[240:241], v[112:113]
    v_pk_fma_f32 v[114:115], v[114:115], v[242:243], v[114:115]
    v_pk_fma_f32 v[116:117], v[116:117], v[244:245], v[116:117]
    v_pk_fma_f32 v[118:119], v[118:119], v[246:247], v[118:119]
    v_pk_fma_f32 v[120:121], v[120:121], v[248:249], v[120:121]
    v_pk_fma_f32 v[122:123], v[122:123], v[250:251], v[122:123]
    v_pk_fma_f32 v[124:125], v[124:125], v[252:253], v[124:125]
    v_pk_fma_f32 v[126:127], v[126:127], v[254:255], v[126:127]
    v_mfma_f32_32x32x16_bf16 v[208:223], a[0:3], a[216:219], v[144:159]
    s_mov_b32 m0, s36
    v_exp_f32 v240, v224
    v_exp_f32 v241, v225
    v_exp_f32 v242, v226
    v_mfma_f32_32x32x16_bf16 v[208:223], a[4:7], a[220:223], v[208:223]
    s_waitcnt lgkmcnt(0)
    v_exp_f32 v243, v227
    v_exp_f32 v244, v228
    v_exp_f32 v245, v229
    v_mfma_f32_32x32x16_bf16 v[208:223], a[8:11], a[224:227], v[208:223]
    s_add_u32 s38, s38, 0x01000000
    v_exp_f32 v246, v230
    v_exp_f32 v247, v231
    v_exp_f32 v248, v232
    v_mfma_f32_32x32x16_bf16 v[208:223], a[12:15], a[228:231], v[208:223]
    s_cmp_ge_i32 s38, s51
    v_add_u32 v1, 512, v1
    v_exp_f32 v249, v233
    v_exp_f32 v250, v234
    v_exp_f32 v251, v235
    v_mfma_f32_32x32x16_bf16 v[208:223], a[16:19], a[232:235], v[208:223]
    v_add_u32 v0, 512, v0
    v_exp_f32 v252, v236
    v_exp_f32 v253, v237
    v_exp_f32 v254, v238
    v_exp_f32_e64 v255, v239
    v_pk_fma_f32 v[64:65], v[64:65], v[240:241], v[64:65]
    v_pk_fma_f32 v[66:67], v[66:67], v[242:243], v[66:67]
    v_pk_fma_f32 v[68:69], v[68:69], v[244:245], v[68:69]
    v_pk_fma_f32 v[70:71], v[70:71], v[246:247], v[70:71]
    v_pk_fma_f32 v[72:73], v[72:73], v[248:249], v[72:73]
    v_pk_fma_f32 v[74:75], v[74:75], v[250:251], v[74:75]
    v_pk_fma_f32 v[76:77], v[76:77], v[252:253], v[76:77]
    v_pk_fma_f32 v[78:79], v[78:79], v[254:255], v[78:79]
    v_pk_fma_f32 v[64:65], v[224:225], v[128:129], v[64:65]
    v_pk_fma_f32 v[66:67], v[226:227], v[130:131], v[66:67]
    v_pk_fma_f32 v[68:69], v[228:229], v[132:133], v[68:69]
    v_pk_fma_f32 v[70:71], v[230:231], v[134:135], v[70:71]
    v_pk_fma_f32 v[72:73], v[232:233], v[136:137], v[72:73]
    v_pk_fma_f32 v[74:75], v[234:235], v[138:139], v[74:75]
    v_pk_fma_f32 v[76:77], v[236:237], v[140:141], v[76:77]
    v_pk_fma_f32 v[78:79], v[238:239], v[142:143], v[78:79]
    v_pk_fma_f32 v[128:129], v[128:129], v[240:241], v[128:129]
    v_pk_fma_f32 v[130:131], v[130:131], v[242:243], v[130:131]
    v_pk_fma_f32 v[132:133], v[132:133], v[244:245], v[132:133]
    v_pk_fma_f32 v[134:135], v[134:135], v[246:247], v[134:135]
    v_pk_fma_f32 v[136:137], v[136:137], v[248:249], v[136:137]
    v_pk_fma_f32 v[138:139], v[138:139], v[250:251], v[138:139]
    v_pk_fma_f32 v[140:141], v[140:141], v[252:253], v[140:141]
    v_pk_fma_f32 v[142:143], v[142:143], v[254:255], v[142:143]
    v_mfma_f32_32x32x16_bf16 v[224:239], a[20:23], a[216:219], v[160:175]
    s_cbranch_scc1 k2_e20
k2_e10:
    v_exp_f32 v240, v208
    v_exp_f32 v241, v209
    v_exp_f32 v242, v210
    v_mfma_f32_32x32x16_bf16 v[224:239], a[24:27], a[220:223], v[224:239]
    v_exp_f32 v243, v211
    v_exp_f32 v244, v212
    v_exp_f32 v245, v213
    v_mfma_f32_32x32x16_bf16 v[224:239], a[28:31], a[224:227], v[224:239]
    ds_read_u16 v2, v1 offset:512
    v_exp_f32 v246, v214
    v_exp_f32 v247, v215
    v_exp_f32 v248, v216
    v_mfma_f32_32x32x16_bf16 v[224:239], a[32:35], a[228:231], v[224:239]
    ds_read_u16 v4, v1 offset:544
    v_exp_f32 v249, v217
    v_exp_f32 v250, v218
    v_exp_f32 v251, v219
    v_mfma_f32_32x32x16_bf16 v[224:239], a[36:39], a[232:235], v[224:239]
    ds_read_u16 v6, v1 offset:576
    v_exp_f32 v252, v220
    v_exp_f32 v253, v221
    v_exp_f32 v254, v222
    v_exp_f32_e64 v255, v223
    v_pk_fma_f32 v[16:17], v[16:17], v[240:241], v[16:17]
    v_pk_fma_f32 v[18:19], v[18:19], v[242:243], v[18:19]
    v_pk_fma_f32 v[20:21], v[20:21], v[244:245], v[20:21]
    v_pk_fma_f32 v[22:23], v[22:23], v[246:247], v[22:23]
    v_pk_fma_f32 v[24:25], v[24:25], v[248:249], v[24:25]
    v_pk_fma_f32 v[26:27], v[26:27], v[250:251], v[26:27]
    v_pk_fma_f32 v[28:29], v[28:29], v[252:253], v[28:29]
    v_pk_fma_f32 v[30:31], v[30:31], v[254:255], v[30:31]
    v_pk_fma_f32 v[16:17], v[208:209], v[80:81], v[16:17]
    v_pk_fma_f32 v[18:19], v[210:211], v[82:83], v[18:19]
    v_pk_fma_f32 v[20:21], v[212:213], v[84:85], v[20:21]
    v_pk_fma_f32 v[22:23], v[214:215], v[86:87], v[22:23]
    v_pk_fma_f32 v[24:25], v[216:217], v[88:89], v[24:25]
    v_pk_fma_f32 v[26:27], v[218:219], v[90:91], v[26:27]
    v_pk_fma_f32 v[28:29], v[220:221], v[92:93], v[28:29]
    v_pk_fma_f32 v[30:31], v[222:223], v[94:95], v[30:31]
    v_pk_fma_f32 v[80:81], v[80:81], v[240:241], v[80:81]
    v_pk_fma_f32 v[82:83], v[82:83], v[242:243], v[82:83]
    v_pk_fma_f32 v[84:85], v[84:85], v[244:245], v[84:85]
    v_pk_fma_f32 v[86:87], v[86:87], v[246:247], v[86:87]
    v_pk_fma_f32 v[88:89], v[88:89], v[248:249], v[88:89]
    v_pk_fma_f32 v[90:91], v[90:91], v[250:251], v[90:91]
    v_pk_fma_f32 v[92:93], v[92:93], v[252:253], v[92:93]
    v_pk_fma_f32 v[94:95], v[94:95], v[254:255], v[94:95]
    v_mfma_f32_32x32x16_bf16 v[208:223], a[40:43], a[216:219], v[176:191]
    v_exp_f32 v240, v224
    v_exp_f32 v241, v225
    v_exp_f32 v242, v226
    v_mfma_f32_32x32x16_bf16 v[208:223], a[44:47], a[220:223], v[208:223]
    v_exp_f32 v243, v227
    v_exp_f32 v244, v228
    v_exp_f32 v245, v229
    v_mfma_f32_32x32x16_bf16 v[208:223], a[48:51], a[224:227], v[208:223]
    v_exp_f32 v246, v230
    v_exp_f32 v247, v231
    v_exp_f32 v248, v232
    v_mfma_f32_32x32x16_bf16 v[208:223], a[52:55], a[228:231], v[208:223]
    ds_read_u16 v8, v1 offset:608
    v_exp_f32 v249, v233
    v_exp_f32 v250, v234
    v_exp_f32 v251, v235
    v_mfma_f32_32x32x16_bf16 v[208:223], a[56:59], a[232:235], v[208:223]
    ds_read_b32 v10, v0 offset:516
    v_exp_f32 v252, v236
    v_exp_f32 v253, v237
    v_exp_f32 v254, v238
    v_exp_f32 v255, v239
    v_pk_fma_f32 v[32:33], v[32:33], v[240:241], v[32:33]
    v_pk_fma_f32 v[34:35], v[34:35], v[242:243], v[34:35]
    v_pk_fma_f32 v[36:37], v[36:37], v[244:245], v[36:37]
    v_pk_fma_f32 v[38:39], v[38:39], v[246:247], v[38:39]
    v_pk_fma_f32 v[40:41], v[40:41], v[248:249], v[40:41]
    v_pk_fma_f32 v[42:43], v[42:43], v[250:251], v[42:43]
    v_pk_fma_f32 v[44:45], v[44:45], v[252:253], v[44:45]
    v_pk_fma_f32 v[46:47], v[46:47], v[254:255], v[46:47]
    v_pk_fma_f32 v[32:33], v[224:225], v[96:97], v[32:33]
    v_pk_fma_f32 v[34:35], v[226:227], v[98:99], v[34:35]
    v_pk_fma_f32 v[36:37], v[228:229], v[100:101], v[36:37]
    v_pk_fma_f32 v[38:39], v[230:231], v[102:103], v[38:39]
    v_pk_fma_f32 v[40:41], v[232:233], v[104:105], v[40:41]
    v_pk_fma_f32 v[42:43], v[234:235], v[106:107], v[42:43]
    v_pk_fma_f32 v[44:45], v[236:237], v[108:109], v[44:45]
    v_pk_fma_f32 v[46:47], v[238:239], v[110:111], v[46:47]
    v_pk_fma_f32 v[96:97], v[96:97], v[240:241], v[96:97]
    v_pk_fma_f32 v[98:99], v[98:99], v[242:243], v[98:99]
    v_pk_fma_f32 v[100:101], v[100:101], v[244:245], v[100:101]
    v_pk_fma_f32 v[102:103], v[102:103], v[246:247], v[102:103]
    v_pk_fma_f32 v[104:105], v[104:105], v[248:249], v[104:105]
    v_pk_fma_f32 v[106:107], v[106:107], v[250:251], v[106:107]
    v_pk_fma_f32 v[108:109], v[108:109], v[252:253], v[108:109]
    v_pk_fma_f32 v[110:111], v[110:111], v[254:255], v[110:111]
    v_mfma_f32_32x32x16_bf16 v[224:239], a[60:63], a[216:219], v[192:207]
    s_waitcnt vmcnt(1) lgkmcnt(0)
    ds_read_b128 a[216:219], v12 offset:5248
    buffer_load_dwordx4 v[2:3], s[8:11], s33 idxen offen offset:0 lds
    v_exp_f32 v240, v208
    v_exp_f32 v241, v209
    v_exp_f32 v242, v210
    v_mfma_f32_32x32x16_bf16 v[224:239], a[64:67], a[220:223], v[224:239]
    ds_read_b128 a[220:223], v12 offset:5280
    buffer_load_dwordx4 v[4:5], s[8:11], s34 idxen offen offset:1056 lds
    v_exp_f32 v243, v211
    v_exp_f32 v244, v212
    v_exp_f32 v245, v213
    v_mfma_f32_32x32x16_bf16 v[224:239], a[68:71], a[224:227], v[224:239]
    ds_read_b128 a[224:227], v12 offset:5312
    buffer_load_dwordx4 v[6:7], s[8:11], s35 idxen offen offset:2112 lds
    buffer_load_dwordx4 v[8:9], s[8:11], 0 idxen offen offset:3168 lds
    v_exp_f32 v246, v214
    v_exp_f32 v247, v215
    v_exp_f32 v248, v216
    v_mfma_f32_32x32x16_bf16 v[224:239], a[72:75], a[228:231], v[224:239]
    s_mov_b32 m0, s66
    ds_read_b128 a[228:231], v12 offset:5344
    v_exp_f32 v249, v217
    v_exp_f32 v250, v218
    v_exp_f32 v251, v219
    v_mfma_f32_32x32x16_bf16 v[224:239], a[76:79], a[232:235], v[224:239]
    s_waitcnt vmcnt(4) lgkmcnt(2)
    ds_read_b128 a[232:235], v13 offset:9472
    buffer_load_dwordx4 v[10:11], s[12:15], 0 idxen offen lds
    v_exp_f32 v252, v220
    v_exp_f32 v253, v221
    v_exp_f32 v254, v222
    v_exp_f32_e64 v255, v223
    v_pk_fma_f32 v[48:49], v[48:49], v[240:241], v[48:49]
    v_pk_fma_f32 v[50:51], v[50:51], v[242:243], v[50:51]
    v_pk_fma_f32 v[52:53], v[52:53], v[244:245], v[52:53]
    v_pk_fma_f32 v[54:55], v[54:55], v[246:247], v[54:55]
    v_pk_fma_f32 v[56:57], v[56:57], v[248:249], v[56:57]
    v_pk_fma_f32 v[58:59], v[58:59], v[250:251], v[58:59]
    v_pk_fma_f32 v[60:61], v[60:61], v[252:253], v[60:61]
    v_pk_fma_f32 v[62:63], v[62:63], v[254:255], v[62:63]
    v_pk_fma_f32 v[48:49], v[208:209], v[112:113], v[48:49]
    v_pk_fma_f32 v[50:51], v[210:211], v[114:115], v[50:51]
    v_pk_fma_f32 v[52:53], v[212:213], v[116:117], v[52:53]
    v_pk_fma_f32 v[54:55], v[214:215], v[118:119], v[54:55]
    v_pk_fma_f32 v[56:57], v[216:217], v[120:121], v[56:57]
    v_pk_fma_f32 v[58:59], v[218:219], v[122:123], v[58:59]
    v_pk_fma_f32 v[60:61], v[220:221], v[124:125], v[60:61]
    v_pk_fma_f32 v[62:63], v[222:223], v[126:127], v[62:63]
    v_pk_fma_f32 v[112:113], v[112:113], v[240:241], v[112:113]
    v_pk_fma_f32 v[114:115], v[114:115], v[242:243], v[114:115]
    v_pk_fma_f32 v[116:117], v[116:117], v[244:245], v[116:117]
    v_pk_fma_f32 v[118:119], v[118:119], v[246:247], v[118:119]
    v_pk_fma_f32 v[120:121], v[120:121], v[248:249], v[120:121]
    v_pk_fma_f32 v[122:123], v[122:123], v[250:251], v[122:123]
    v_pk_fma_f32 v[124:125], v[124:125], v[252:253], v[124:125]
    v_pk_fma_f32 v[126:127], v[126:127], v[254:255], v[126:127]
    v_mfma_f32_32x32x16_bf16 v[208:223], a[0:3], a[216:219], v[144:159]
    s_mov_b32 m0, s65
    v_exp_f32 v240, v224
    v_exp_f32 v241, v225
    v_exp_f32 v242, v226
    v_mfma_f32_32x32x16_bf16 v[208:223], a[4:7], a[220:223], v[208:223]
    s_waitcnt lgkmcnt(0)
    v_exp_f32 v243, v227
    v_exp_f32 v244, v228
    v_exp_f32 v245, v229
    v_mfma_f32_32x32x16_bf16 v[208:223], a[8:11], a[224:227], v[208:223]
    s_add_u32 s38, s38, 0x01000000
    v_exp_f32 v246, v230
    v_exp_f32 v247, v231
    v_exp_f32 v248, v232
    v_mfma_f32_32x32x16_bf16 v[208:223], a[12:15], a[228:231], v[208:223]
    s_cmp_ge_i32 s38, s51
    v_exp_f32 v249, v233
    v_exp_f32 v250, v234
    v_exp_f32 v251, v235
    v_mfma_f32_32x32x16_bf16 v[208:223], a[16:19], a[232:235], v[208:223]
    v_exp_f32 v252, v236
    v_exp_f32 v253, v237
    v_exp_f32 v254, v238
    v_exp_f32_e64 v255, v239
    v_pk_fma_f32 v[64:65], v[64:65], v[240:241], v[64:65]
    v_pk_fma_f32 v[66:67], v[66:67], v[242:243], v[66:67]
    v_pk_fma_f32 v[68:69], v[68:69], v[244:245], v[68:69]
    v_pk_fma_f32 v[70:71], v[70:71], v[246:247], v[70:71]
    v_pk_fma_f32 v[72:73], v[72:73], v[248:249], v[72:73]
    v_pk_fma_f32 v[74:75], v[74:75], v[250:251], v[74:75]
    v_pk_fma_f32 v[76:77], v[76:77], v[252:253], v[76:77]
    v_pk_fma_f32 v[78:79], v[78:79], v[254:255], v[78:79]
    v_pk_fma_f32 v[64:65], v[224:225], v[128:129], v[64:65]
    v_pk_fma_f32 v[66:67], v[226:227], v[130:131], v[66:67]
    v_pk_fma_f32 v[68:69], v[228:229], v[132:133], v[68:69]
    v_pk_fma_f32 v[70:71], v[230:231], v[134:135], v[70:71]
    v_pk_fma_f32 v[72:73], v[232:233], v[136:137], v[72:73]
    v_pk_fma_f32 v[74:75], v[234:235], v[138:139], v[74:75]
    v_pk_fma_f32 v[76:77], v[236:237], v[140:141], v[76:77]
    v_pk_fma_f32 v[78:79], v[238:239], v[142:143], v[78:79]
    v_pk_fma_f32 v[128:129], v[128:129], v[240:241], v[128:129]
    v_pk_fma_f32 v[130:131], v[130:131], v[242:243], v[130:131]
    v_pk_fma_f32 v[132:133], v[132:133], v[244:245], v[132:133]
    v_pk_fma_f32 v[134:135], v[134:135], v[246:247], v[134:135]
    v_pk_fma_f32 v[136:137], v[136:137], v[248:249], v[136:137]
    v_pk_fma_f32 v[138:139], v[138:139], v[250:251], v[138:139]
    v_pk_fma_f32 v[140:141], v[140:141], v[252:253], v[140:141]
    v_pk_fma_f32 v[142:143], v[142:143], v[254:255], v[142:143]
    v_mfma_f32_32x32x16_bf16 v[224:239], a[20:23], a[216:219], v[160:175]
    s_cbranch_scc0 k2_u11
k2_e21:
    s_cmp_ge_i32 s38, s49
    s_cbranch_scc1 k2_lm1
k2_u21:
    v_exp_f32 v240, v208
    v_exp_f32 v241, v209
    v_exp_f32 v242, v210
    v_mfma_f32_32x32x16_bf16 v[224:239], a[24:27], a[220:223], v[224:239]
    v_exp_f32 v243, v211
    v_exp_f32 v244, v212
    v_exp_f32 v245, v213
    v_mfma_f32_32x32x16_bf16 v[224:239], a[28:31], a[224:227], v[224:239]
    ds_read_u16 v2, v1 offset:768
    v_exp_f32 v246, v214
    v_exp_f32 v247, v215
    v_exp_f32 v248, v216
    v_mfma_f32_32x32x16_bf16 v[224:239], a[32:35], a[228:231], v[224:239]
    ds_read_u16 v4, v1 offset:800
    v_exp_f32 v249, v217
    v_exp_f32 v250, v218
    v_exp_f32 v251, v219
    v_mfma_f32_32x32x16_bf16 v[224:239], a[36:39], a[232:235], v[224:239]
    ds_read_u16 v6, v1 offset:832
    v_exp_f32 v252, v220
    v_exp_f32 v253, v221
    v_exp_f32 v254, v222
    v_exp_f32_e64 v255, v223
    v_pk_fma_f32 v[16:17], v[16:17], v[240:241], v[16:17]
    v_pk_fma_f32 v[18:19], v[18:19], v[242:243], v[18:19]
    v_pk_fma_f32 v[20:21], v[20:21], v[244:245], v[20:21]
    v_pk_fma_f32 v[22:23], v[22:23], v[246:247], v[22:23]
    v_pk_fma_f32 v[24:25], v[24:25], v[248:249], v[24:25]
    v_pk_fma_f32 v[26:27], v[26:27], v[250:251], v[26:27]
    v_pk_fma_f32 v[28:29], v[28:29], v[252:253], v[28:29]
    v_pk_fma_f32 v[30:31], v[30:31], v[254:255], v[30:31]
    v_pk_fma_f32 v[16:17], v[208:209], v[80:81], v[16:17]
    v_pk_fma_f32 v[18:19], v[210:211], v[82:83], v[18:19]
    v_pk_fma_f32 v[20:21], v[212:213], v[84:85], v[20:21]
    v_pk_fma_f32 v[22:23], v[214:215], v[86:87], v[22:23]
    v_pk_fma_f32 v[24:25], v[216:217], v[88:89], v[24:25]
    v_pk_fma_f32 v[26:27], v[218:219], v[90:91], v[26:27]
    v_pk_fma_f32 v[28:29], v[220:221], v[92:93], v[28:29]
    v_pk_fma_f32 v[30:31], v[222:223], v[94:95], v[30:31]
    v_pk_fma_f32 v[80:81], v[80:81], v[240:241], v[80:81]
    v_pk_fma_f32 v[82:83], v[82:83], v[242:243], v[82:83]
    v_pk_fma_f32 v[84:85], v[84:85], v[244:245], v[84:85]
    v_pk_fma_f32 v[86:87], v[86:87], v[246:247], v[86:87]
    v_pk_fma_f32 v[88:89], v[88:89], v[248:249], v[88:89]
    v_pk_fma_f32 v[90:91], v[90:91], v[250:251], v[90:91]
    v_pk_fma_f32 v[92:93], v[92:93], v[252:253], v[92:93]
    v_pk_fma_f32 v[94:95], v[94:95], v[254:255], v[94:95]
    v_mfma_f32_32x32x16_bf16 v[208:223], a[40:43], a[216:219], v[176:191]
    s_add_u32 s38, s38, 0x01000000
    v_exp_f32 v240, v224
    v_exp_f32 v241, v225
    v_exp_f32 v242, v226
    v_mfma_f32_32x32x16_bf16 v[208:223], a[44:47], a[220:223], v[208:223]
    s_cmp_ge_i32 s38, s49
    v_exp_f32 v243, v227
    v_exp_f32 v244, v228
    v_exp_f32 v245, v229
    v_mfma_f32_32x32x16_bf16 v[208:223], a[48:51], a[224:227], v[208:223]
    v_exp_f32 v246, v230
    v_exp_f32 v247, v231
    v_exp_f32 v248, v232
    v_mfma_f32_32x32x16_bf16 v[208:223], a[52:55], a[228:231], v[208:223]
    ds_read_u16 v8, v1 offset:864
    v_exp_f32 v249, v233
    v_exp_f32 v250, v234
    v_exp_f32 v251, v235
    v_mfma_f32_32x32x16_bf16 v[208:223], a[56:59], a[232:235], v[208:223]
    ds_read_b32 v10, v0 offset:772
    v_exp_f32 v252, v236
    v_exp_f32 v253, v237
    v_exp_f32 v254, v238
    v_exp_f32_e64 v255, v239
    v_pk_fma_f32 v[32:33], v[32:33], v[240:241], v[32:33]
    v_pk_fma_f32 v[34:35], v[34:35], v[242:243], v[34:35]
    v_pk_fma_f32 v[36:37], v[36:37], v[244:245], v[36:37]
    v_pk_fma_f32 v[38:39], v[38:39], v[246:247], v[38:39]
    v_pk_fma_f32 v[40:41], v[40:41], v[248:249], v[40:41]
    v_pk_fma_f32 v[42:43], v[42:43], v[250:251], v[42:43]
    v_pk_fma_f32 v[44:45], v[44:45], v[252:253], v[44:45]
    v_pk_fma_f32 v[46:47], v[46:47], v[254:255], v[46:47]
    v_pk_fma_f32 v[32:33], v[224:225], v[96:97], v[32:33]
    v_pk_fma_f32 v[34:35], v[226:227], v[98:99], v[34:35]
    v_pk_fma_f32 v[36:37], v[228:229], v[100:101], v[36:37]
    v_pk_fma_f32 v[38:39], v[230:231], v[102:103], v[38:39]
    v_pk_fma_f32 v[40:41], v[232:233], v[104:105], v[40:41]
    v_pk_fma_f32 v[42:43], v[234:235], v[106:107], v[42:43]
    v_pk_fma_f32 v[44:45], v[236:237], v[108:109], v[44:45]
    v_pk_fma_f32 v[46:47], v[238:239], v[110:111], v[46:47]
    v_pk_fma_f32 v[96:97], v[96:97], v[240:241], v[96:97]
    v_pk_fma_f32 v[98:99], v[98:99], v[242:243], v[98:99]
    v_pk_fma_f32 v[100:101], v[100:101], v[244:245], v[100:101]
    v_pk_fma_f32 v[102:103], v[102:103], v[246:247], v[102:103]
    v_pk_fma_f32 v[104:105], v[104:105], v[248:249], v[104:105]
    v_pk_fma_f32 v[106:107], v[106:107], v[250:251], v[106:107]
    v_pk_fma_f32 v[108:109], v[108:109], v[252:253], v[108:109]
    v_pk_fma_f32 v[110:111], v[110:111], v[254:255], v[110:111]
    v_mfma_f32_32x32x16_bf16 v[224:239], a[60:63], a[216:219], v[192:207]
    s_waitcnt vmcnt(0)
    ds_read_b128 a[216:219], v12 offset:0
    v_exp_f32 v240, v208
    v_exp_f32 v241, v209
    v_exp_f32 v242, v210
    v_mfma_f32_32x32x16_bf16 v[224:239], a[64:67], a[220:223], v[224:239]
    ds_read_b128 a[220:223], v12 offset:32
    v_exp_f32 v243, v211
    v_exp_f32 v244, v212
    v_exp_f32 v245, v213
    v_mfma_f32_32x32x16_bf16 v[224:239], a[68:71], a[224:227], v[224:239]
    ds_read_b128 a[224:227], v12 offset:64
    v_exp_f32 v246, v214
    v_exp_f32 v247, v215
    v_exp_f32 v248, v216
    v_mfma_f32_32x32x16_bf16 v[224:239], a[72:75], a[228:231], v[224:239]
    ds_read_b128 a[228:231], v12 offset:96
    v_exp_f32 v249, v217
    v_exp_f32 v250, v218
    v_exp_f32 v251, v219
    v_mfma_f32_32x32x16_bf16 v[224:239], a[76:79], a[232:235], v[224:239]
    s_waitcnt lgkmcnt(2)
    ds_read_b128 a[232:235], v13 offset:4224
    v_exp_f32 v252, v220
    v_exp_f32 v253, v221
    v_exp_f32 v254, v222
    v_exp_f32 v255, v223
    v_pk_fma_f32 v[48:49], v[48:49], v[240:241], v[48:49]
    v_pk_fma_f32 v[50:51], v[50:51], v[242:243], v[50:51]
    v_pk_fma_f32 v[52:53], v[52:53], v[244:245], v[52:53]
    v_pk_fma_f32 v[54:55], v[54:55], v[246:247], v[54:55]
    v_pk_fma_f32 v[56:57], v[56:57], v[248:249], v[56:57]
    v_pk_fma_f32 v[58:59], v[58:59], v[250:251], v[58:59]
    v_pk_fma_f32 v[60:61], v[60:61], v[252:253], v[60:61]
    v_pk_fma_f32 v[62:63], v[62:63], v[254:255], v[62:63]
    v_pk_fma_f32 v[48:49], v[208:209], v[112:113], v[48:49]
    v_pk_fma_f32 v[50:51], v[210:211], v[114:115], v[50:51]
    v_pk_fma_f32 v[52:53], v[212:213], v[116:117], v[52:53]
    v_pk_fma_f32 v[54:55], v[214:215], v[118:119], v[54:55]
    v_pk_fma_f32 v[56:57], v[216:217], v[120:121], v[56:57]
    v_pk_fma_f32 v[58:59], v[218:219], v[122:123], v[58:59]
    v_pk_fma_f32 v[60:61], v[220:221], v[124:125], v[60:61]
    v_pk_fma_f32 v[62:63], v[222:223], v[126:127], v[62:63]
    v_pk_fma_f32 v[112:113], v[112:113], v[240:241], v[112:113]
    v_pk_fma_f32 v[114:115], v[114:115], v[242:243], v[114:115]
    v_pk_fma_f32 v[116:117], v[116:117], v[244:245], v[116:117]
    v_pk_fma_f32 v[118:119], v[118:119], v[246:247], v[118:119]
    v_pk_fma_f32 v[120:121], v[120:121], v[248:249], v[120:121]
    v_pk_fma_f32 v[122:123], v[122:123], v[250:251], v[122:123]
    v_pk_fma_f32 v[124:125], v[124:125], v[252:253], v[124:125]
    v_pk_fma_f32 v[126:127], v[126:127], v[254:255], v[126:127]
    v_mfma_f32_32x32x16_bf16 v[208:223], a[0:3], a[216:219], v[144:159]
    buffer_load_dwordx4 v[2:3], s[8:11], s33 idxen offen offset:0 lds
    buffer_load_dwordx4 v[4:5], s[8:11], s34 idxen offen offset:1056 lds
    v_exp_f32 v240, v224
    v_exp_f32 v241, v225
    v_exp_f32 v242, v226
    v_mfma_f32_32x32x16_bf16 v[208:223], a[4:7], a[220:223], v[208:223]
    s_waitcnt lgkmcnt(0)
    buffer_load_dwordx4 v[6:7], s[8:11], s35 idxen offen offset:2112 lds
    buffer_load_dwordx4 v[8:9], s[8:11], 0 idxen offen offset:3168 lds
    v_exp_f32 v243, v227
    v_exp_f32 v244, v228
    v_exp_f32 v245, v229
    v_mfma_f32_32x32x16_bf16 v[208:223], a[8:11], a[224:227], v[208:223]
    s_mov_b32 m0, s67
    v_add_u32 v1, 512, v1
    v_exp_f32 v246, v230
    v_exp_f32 v247, v231
    v_exp_f32 v248, v232
    v_mfma_f32_32x32x16_bf16 v[208:223], a[12:15], a[228:231], v[208:223]
    buffer_load_dwordx4 v[10:11], s[12:15], 0 idxen offen lds
    v_exp_f32 v249, v233
    v_exp_f32 v250, v234
    v_exp_f32 v251, v235
    v_mfma_f32_32x32x16_bf16 v[208:223], a[16:19], a[232:235], v[208:223]
    s_mov_b32 m0, s36
    v_add_u32 v0, 512, v0
    v_exp_f32 v252, v236
    v_exp_f32 v253, v237
    v_exp_f32 v254, v238
    v_exp_f32_e64 v255, v239
    v_pk_fma_f32 v[64:65], v[64:65], v[240:241], v[64:65]
    v_pk_fma_f32 v[66:67], v[66:67], v[242:243], v[66:67]
    v_pk_fma_f32 v[68:69], v[68:69], v[244:245], v[68:69]
    v_pk_fma_f32 v[70:71], v[70:71], v[246:247], v[70:71]
    v_pk_fma_f32 v[72:73], v[72:73], v[248:249], v[72:73]
    v_pk_fma_f32 v[74:75], v[74:75], v[250:251], v[74:75]
    v_pk_fma_f32 v[76:77], v[76:77], v[252:253], v[76:77]
    v_pk_fma_f32 v[78:79], v[78:79], v[254:255], v[78:79]
    v_pk_fma_f32 v[64:65], v[224:225], v[128:129], v[64:65]
    v_pk_fma_f32 v[66:67], v[226:227], v[130:131], v[66:67]
    v_pk_fma_f32 v[68:69], v[228:229], v[132:133], v[68:69]
    v_pk_fma_f32 v[70:71], v[230:231], v[134:135], v[70:71]
    v_pk_fma_f32 v[72:73], v[232:233], v[136:137], v[72:73]
    v_pk_fma_f32 v[74:75], v[234:235], v[138:139], v[74:75]
    v_pk_fma_f32 v[76:77], v[236:237], v[140:141], v[76:77]
    v_pk_fma_f32 v[78:79], v[238:239], v[142:143], v[78:79]
    v_pk_fma_f32 v[128:129], v[128:129], v[240:241], v[128:129]
    v_pk_fma_f32 v[130:131], v[130:131], v[242:243], v[130:131]
    v_pk_fma_f32 v[132:133], v[132:133], v[244:245], v[132:133]
    v_pk_fma_f32 v[134:135], v[134:135], v[246:247], v[134:135]
    v_pk_fma_f32 v[136:137], v[136:137], v[248:249], v[136:137]
    v_pk_fma_f32 v[138:139], v[138:139], v[250:251], v[138:139]
    v_pk_fma_f32 v[140:141], v[140:141], v[252:253], v[140:141]
    v_pk_fma_f32 v[142:143], v[142:143], v[254:255], v[142:143]
    v_mfma_f32_32x32x16_bf16 v[224:239], a[20:23], a[216:219], v[160:175]
    s_cbranch_scc1 k2_lm0
k2_e20:
    v_exp_f32 v240, v208
    v_exp_f32 v241, v209
    v_exp_f32 v242, v210
    v_mfma_f32_32x32x16_bf16 v[224:239], a[24:27], a[220:223], v[224:239]
    v_exp_f32 v243, v211
    v_exp_f32 v244, v212
    v_exp_f32 v245, v213
    v_mfma_f32_32x32x16_bf16 v[224:239], a[28:31], a[224:227], v[224:239]
    ds_read_u16 v2, v1 offset:512
    v_exp_f32 v246, v214
    v_exp_f32 v247, v215
    v_exp_f32 v248, v216
    v_mfma_f32_32x32x16_bf16 v[224:239], a[32:35], a[228:231], v[224:239]
    ds_read_u16 v4, v1 offset:544
    v_exp_f32 v249, v217
    v_exp_f32 v250, v218
    v_exp_f32 v251, v219
    v_mfma_f32_32x32x16_bf16 v[224:239], a[36:39], a[232:235], v[224:239]
    ds_read_u16 v6, v1 offset:576
    v_exp_f32 v252, v220
    v_exp_f32 v253, v221
    v_exp_f32 v254, v222
    v_exp_f32_e64 v255, v223
    v_pk_fma_f32 v[16:17], v[16:17], v[240:241], v[16:17]
    v_pk_fma_f32 v[18:19], v[18:19], v[242:243], v[18:19]
    v_pk_fma_f32 v[20:21], v[20:21], v[244:245], v[20:21]
    v_pk_fma_f32 v[22:23], v[22:23], v[246:247], v[22:23]
    v_pk_fma_f32 v[24:25], v[24:25], v[248:249], v[24:25]
    v_pk_fma_f32 v[26:27], v[26:27], v[250:251], v[26:27]
    v_pk_fma_f32 v[28:29], v[28:29], v[252:253], v[28:29]
    v_pk_fma_f32 v[30:31], v[30:31], v[254:255], v[30:31]
    v_pk_fma_f32 v[16:17], v[208:209], v[80:81], v[16:17]
    v_pk_fma_f32 v[18:19], v[210:211], v[82:83], v[18:19]
    v_pk_fma_f32 v[20:21], v[212:213], v[84:85], v[20:21]
    v_pk_fma_f32 v[22:23], v[214:215], v[86:87], v[22:23]
    v_pk_fma_f32 v[24:25], v[216:217], v[88:89], v[24:25]
    v_pk_fma_f32 v[26:27], v[218:219], v[90:91], v[26:27]
    v_pk_fma_f32 v[28:29], v[220:221], v[92:93], v[28:29]
    v_pk_fma_f32 v[30:31], v[222:223], v[94:95], v[30:31]
    v_pk_fma_f32 v[80:81], v[80:81], v[240:241], v[80:81]
    v_pk_fma_f32 v[82:83], v[82:83], v[242:243], v[82:83]
    v_pk_fma_f32 v[84:85], v[84:85], v[244:245], v[84:85]
    v_pk_fma_f32 v[86:87], v[86:87], v[246:247], v[86:87]
    v_pk_fma_f32 v[88:89], v[88:89], v[248:249], v[88:89]
    v_pk_fma_f32 v[90:91], v[90:91], v[250:251], v[90:91]
    v_pk_fma_f32 v[92:93], v[92:93], v[252:253], v[92:93]
    v_pk_fma_f32 v[94:95], v[94:95], v[254:255], v[94:95]
    v_mfma_f32_32x32x16_bf16 v[208:223], a[40:43], a[216:219], v[176:191]
    s_add_u32 s38, s38, 0x01000000
    v_exp_f32 v240, v224
    v_exp_f32 v241, v225
    v_exp_f32 v242, v226
    v_mfma_f32_32x32x16_bf16 v[208:223], a[44:47], a[220:223], v[208:223]
    s_cmp_ge_i32 s38, s49
    v_exp_f32 v243, v227
    v_exp_f32 v244, v228
    v_exp_f32 v245, v229
    v_mfma_f32_32x32x16_bf16 v[208:223], a[48:51], a[224:227], v[208:223]
    v_exp_f32 v246, v230
    v_exp_f32 v247, v231
    v_exp_f32 v248, v232
    v_mfma_f32_32x32x16_bf16 v[208:223], a[52:55], a[228:231], v[208:223]
    ds_read_u16 v8, v1 offset:608
    v_exp_f32 v249, v233
    v_exp_f32 v250, v234
    v_exp_f32 v251, v235
    v_mfma_f32_32x32x16_bf16 v[208:223], a[56:59], a[232:235], v[208:223]
    ds_read_b32 v10, v0 offset:516
    v_exp_f32 v252, v236
    v_exp_f32 v253, v237
    v_exp_f32 v254, v238
    v_exp_f32_e64 v255, v239
    v_pk_fma_f32 v[32:33], v[32:33], v[240:241], v[32:33]
    v_pk_fma_f32 v[34:35], v[34:35], v[242:243], v[34:35]
    v_pk_fma_f32 v[36:37], v[36:37], v[244:245], v[36:37]
    v_pk_fma_f32 v[38:39], v[38:39], v[246:247], v[38:39]
    v_pk_fma_f32 v[40:41], v[40:41], v[248:249], v[40:41]
    v_pk_fma_f32 v[42:43], v[42:43], v[250:251], v[42:43]
    v_pk_fma_f32 v[44:45], v[44:45], v[252:253], v[44:45]
    v_pk_fma_f32 v[46:47], v[46:47], v[254:255], v[46:47]
    v_pk_fma_f32 v[32:33], v[224:225], v[96:97], v[32:33]
    v_pk_fma_f32 v[34:35], v[226:227], v[98:99], v[34:35]
    v_pk_fma_f32 v[36:37], v[228:229], v[100:101], v[36:37]
    v_pk_fma_f32 v[38:39], v[230:231], v[102:103], v[38:39]
    v_pk_fma_f32 v[40:41], v[232:233], v[104:105], v[40:41]
    v_pk_fma_f32 v[42:43], v[234:235], v[106:107], v[42:43]
    v_pk_fma_f32 v[44:45], v[236:237], v[108:109], v[44:45]
    v_pk_fma_f32 v[46:47], v[238:239], v[110:111], v[46:47]
    v_pk_fma_f32 v[96:97], v[96:97], v[240:241], v[96:97]
    v_pk_fma_f32 v[98:99], v[98:99], v[242:243], v[98:99]
    v_pk_fma_f32 v[100:101], v[100:101], v[244:245], v[100:101]
    v_pk_fma_f32 v[102:103], v[102:103], v[246:247], v[102:103]
    v_pk_fma_f32 v[104:105], v[104:105], v[248:249], v[104:105]
    v_pk_fma_f32 v[106:107], v[106:107], v[250:251], v[106:107]
    v_pk_fma_f32 v[108:109], v[108:109], v[252:253], v[108:109]
    v_pk_fma_f32 v[110:111], v[110:111], v[254:255], v[110:111]
    v_mfma_f32_32x32x16_bf16 v[224:239], a[60:63], a[216:219], v[192:207]
    s_waitcnt vmcnt(0)
    ds_read_b128 a[216:219], v12 offset:5248
    v_exp_f32 v240, v208
    v_exp_f32 v241, v209
    v_exp_f32 v242, v210
    v_mfma_f32_32x32x16_bf16 v[224:239], a[64:67], a[220:223], v[224:239]
    ds_read_b128 a[220:223], v12 offset:5280
    v_exp_f32 v243, v211
    v_exp_f32 v244, v212
    v_exp_f32 v245, v213
    v_mfma_f32_32x32x16_bf16 v[224:239], a[68:71], a[224:227], v[224:239]
    ds_read_b128 a[224:227], v12 offset:5312
    v_exp_f32 v246, v214
    v_exp_f32 v247, v215
    v_exp_f32 v248, v216
    v_mfma_f32_32x32x16_bf16 v[224:239], a[72:75], a[228:231], v[224:239]
    ds_read_b128 a[228:231], v12 offset:5344
    v_exp_f32 v249, v217
    v_exp_f32 v250, v218
    v_exp_f32 v251, v219
    v_mfma_f32_32x32x16_bf16 v[224:239], a[76:79], a[232:235], v[224:239]
    s_waitcnt lgkmcnt(2)
    ds_read_b128 a[232:235], v13 offset:9472
    v_exp_f32 v252, v220
    v_exp_f32 v253, v221
    v_exp_f32 v254, v222
    v_exp_f32 v255, v223
    v_pk_fma_f32 v[48:49], v[48:49], v[240:241], v[48:49]
    v_pk_fma_f32 v[50:51], v[50:51], v[242:243], v[50:51]
    v_pk_fma_f32 v[52:53], v[52:53], v[244:245], v[52:53]
    v_pk_fma_f32 v[54:55], v[54:55], v[246:247], v[54:55]
    v_pk_fma_f32 v[56:57], v[56:57], v[248:249], v[56:57]
    v_pk_fma_f32 v[58:59], v[58:59], v[250:251], v[58:59]
    v_pk_fma_f32 v[60:61], v[60:61], v[252:253], v[60:61]
    v_pk_fma_f32 v[62:63], v[62:63], v[254:255], v[62:63]
    v_pk_fma_f32 v[48:49], v[208:209], v[112:113], v[48:49]
    v_pk_fma_f32 v[50:51], v[210:211], v[114:115], v[50:51]
    v_pk_fma_f32 v[52:53], v[212:213], v[116:117], v[52:53]
    v_pk_fma_f32 v[54:55], v[214:215], v[118:119], v[54:55]
    v_pk_fma_f32 v[56:57], v[216:217], v[120:121], v[56:57]
    v_pk_fma_f32 v[58:59], v[218:219], v[122:123], v[58:59]
    v_pk_fma_f32 v[60:61], v[220:221], v[124:125], v[60:61]
    v_pk_fma_f32 v[62:63], v[222:223], v[126:127], v[62:63]
    v_pk_fma_f32 v[112:113], v[112:113], v[240:241], v[112:113]
    v_pk_fma_f32 v[114:115], v[114:115], v[242:243], v[114:115]
    v_pk_fma_f32 v[116:117], v[116:117], v[244:245], v[116:117]
    v_pk_fma_f32 v[118:119], v[118:119], v[246:247], v[118:119]
    v_pk_fma_f32 v[120:121], v[120:121], v[248:249], v[120:121]
    v_pk_fma_f32 v[122:123], v[122:123], v[250:251], v[122:123]
    v_pk_fma_f32 v[124:125], v[124:125], v[252:253], v[124:125]
    v_pk_fma_f32 v[126:127], v[126:127], v[254:255], v[126:127]
    v_mfma_f32_32x32x16_bf16 v[208:223], a[0:3], a[216:219], v[144:159]
    buffer_load_dwordx4 v[2:3], s[8:11], s33 idxen offen offset:0 lds
    buffer_load_dwordx4 v[4:5], s[8:11], s34 idxen offen offset:1056 lds
    v_exp_f32 v240, v224
    v_exp_f32 v241, v225
    v_exp_f32 v242, v226
    v_mfma_f32_32x32x16_bf16 v[208:223], a[4:7], a[220:223], v[208:223]
    s_waitcnt lgkmcnt(0)
    buffer_load_dwordx4 v[6:7], s[8:11], s35 idxen offen offset:2112 lds
    buffer_load_dwordx4 v[8:9], s[8:11], 0 idxen offen offset:3168 lds
    v_exp_f32 v243, v227
    v_exp_f32 v244, v228
    v_exp_f32 v245, v229
    v_mfma_f32_32x32x16_bf16 v[208:223], a[8:11], a[224:227], v[208:223]
    s_mov_b32 m0, s66
    v_exp_f32 v246, v230
    v_exp_f32 v247, v231
    v_exp_f32 v248, v232
    v_mfma_f32_32x32x16_bf16 v[208:223], a[12:15], a[228:231], v[208:223]
    buffer_load_dwordx4 v[10:11], s[12:15], 0 idxen offen lds
    v_exp_f32 v249, v233
    v_exp_f32 v250, v234
    v_exp_f32 v251, v235
    v_mfma_f32_32x32x16_bf16 v[208:223], a[16:19], a[232:235], v[208:223]
    s_mov_b32 m0, s65
    v_exp_f32 v252, v236
    v_exp_f32 v253, v237
    v_exp_f32 v254, v238
    v_exp_f32_e64 v255, v239
    v_pk_fma_f32 v[64:65], v[64:65], v[240:241], v[64:65]
    v_pk_fma_f32 v[66:67], v[66:67], v[242:243], v[66:67]
    v_pk_fma_f32 v[68:69], v[68:69], v[244:245], v[68:69]
    v_pk_fma_f32 v[70:71], v[70:71], v[246:247], v[70:71]
    v_pk_fma_f32 v[72:73], v[72:73], v[248:249], v[72:73]
    v_pk_fma_f32 v[74:75], v[74:75], v[250:251], v[74:75]
    v_pk_fma_f32 v[76:77], v[76:77], v[252:253], v[76:77]
    v_pk_fma_f32 v[78:79], v[78:79], v[254:255], v[78:79]
    v_pk_fma_f32 v[64:65], v[224:225], v[128:129], v[64:65]
    v_pk_fma_f32 v[66:67], v[226:227], v[130:131], v[66:67]
    v_pk_fma_f32 v[68:69], v[228:229], v[132:133], v[68:69]
    v_pk_fma_f32 v[70:71], v[230:231], v[134:135], v[70:71]
    v_pk_fma_f32 v[72:73], v[232:233], v[136:137], v[72:73]
    v_pk_fma_f32 v[74:75], v[234:235], v[138:139], v[74:75]
    v_pk_fma_f32 v[76:77], v[236:237], v[140:141], v[76:77]
    v_pk_fma_f32 v[78:79], v[238:239], v[142:143], v[78:79]
    v_pk_fma_f32 v[128:129], v[128:129], v[240:241], v[128:129]
    v_pk_fma_f32 v[130:131], v[130:131], v[242:243], v[130:131]
    v_pk_fma_f32 v[132:133], v[132:133], v[244:245], v[132:133]
    v_pk_fma_f32 v[134:135], v[134:135], v[246:247], v[134:135]
    v_pk_fma_f32 v[136:137], v[136:137], v[248:249], v[136:137]
    v_pk_fma_f32 v[138:139], v[138:139], v[250:251], v[138:139]
    v_pk_fma_f32 v[140:141], v[140:141], v[252:253], v[140:141]
    v_pk_fma_f32 v[142:143], v[142:143], v[254:255], v[142:143]
    v_mfma_f32_32x32x16_bf16 v[224:239], a[20:23], a[216:219], v[160:175]
    s_cbranch_scc0 k2_u21
k2_lm1:
    s_mov_b64 exec, -1
    ds_read_u16 v2, v1 offset:768
    ds_read_u16 v4, v1 offset:800
    v_exp_f32 v240, v208
    v_exp_f32 v241, v209
    v_exp_f32 v242, v210
    v_mfma_f32_32x32x16_bf16 v[224:239], a[24:27], a[220:223], v[224:239]
    s_add_u32 s38, s38, 0x01000000
    v_cmp_le_u32 s[42:43], s38, v14
    v_exp_f32 v243, v211
    v_exp_f32 v244, v212
    v_exp_f32 v245, v213
    v_mfma_f32_32x32x16_bf16 v[224:239], a[28:31], a[224:227], v[224:239]
    s_cmp_eq_u32 s38, s39
    ds_read_u16 v6, v1 offset:832
    ds_read_u16 v8, v1 offset:864
    v_exp_f32 v246, v214
    v_exp_f32 v247, v215
    v_exp_f32 v248, v216
    v_mfma_f32_32x32x16_bf16 v[224:239], a[32:35], a[228:231], v[224:239]
    ds_read_b32 v10, v0 offset:772
    v_exp_f32 v249, v217
    v_exp_f32 v250, v218
    v_exp_f32 v251, v219
    v_mfma_f32_32x32x16_bf16 v[224:239], a[36:39], a[232:235], v[224:239]
    s_mov_b64 exec, s[42:43]
    v_exp_f32 v252, v220
    v_exp_f32 v253, v221
    v_exp_f32 v254, v222
    v_exp_f32 v255, v223
    v_pk_fma_f32 v[16:17], v[16:17], v[240:241], v[16:17]
    v_pk_fma_f32 v[18:19], v[18:19], v[242:243], v[18:19]
    v_pk_fma_f32 v[20:21], v[20:21], v[244:245], v[20:21]
    v_pk_fma_f32 v[22:23], v[22:23], v[246:247], v[22:23]
    v_pk_fma_f32 v[24:25], v[24:25], v[248:249], v[24:25]
    v_pk_fma_f32 v[26:27], v[26:27], v[250:251], v[26:27]
    v_pk_fma_f32 v[28:29], v[28:29], v[252:253], v[28:29]
    v_pk_fma_f32 v[30:31], v[30:31], v[254:255], v[30:31]
    v_pk_fma_f32 v[16:17], v[208:209], v[80:81], v[16:17]
    v_pk_fma_f32 v[18:19], v[210:211], v[82:83], v[18:19]
    v_pk_fma_f32 v[20:21], v[212:213], v[84:85], v[20:21]
    v_pk_fma_f32 v[22:23], v[214:215], v[86:87], v[22:23]
    v_pk_fma_f32 v[24:25], v[216:217], v[88:89], v[24:25]
    v_pk_fma_f32 v[26:27], v[218:219], v[90:91], v[26:27]
    v_pk_fma_f32 v[28:29], v[220:221], v[92:93], v[28:29]
    v_pk_fma_f32 v[30:31], v[222:223], v[94:95], v[30:31]
    v_pk_fma_f32 v[80:81], v[80:81], v[240:241], v[80:81]
    v_pk_fma_f32 v[82:83], v[82:83], v[242:243], v[82:83]
    v_pk_fma_f32 v[84:85], v[84:85], v[244:245], v[84:85]
    v_pk_fma_f32 v[86:87], v[86:87], v[246:247], v[86:87]
    v_pk_fma_f32 v[88:89], v[88:89], v[248:249], v[88:89]
    v_pk_fma_f32 v[90:91], v[90:91], v[250:251], v[90:91]
    v_pk_fma_f32 v[92:93], v[92:93], v[252:253], v[92:93]
    v_pk_fma_f32 v[94:95], v[94:95], v[254:255], v[94:95]
    v_mfma_f32_32x32x16_bf16 v[208:223], a[40:43], a[216:219], v[176:191]
    v_exp_f32 v240, v224
    v_exp_f32 v241, v225
    v_exp_f32 v242, v226
    v_mfma_f32_32x32x16_bf16 v[208:223], a[44:47], a[220:223], v[208:223]
    v_exp_f32 v243, v227
    v_exp_f32 v244, v228
    v_exp_f32 v245, v229
    v_mfma_f32_32x32x16_bf16 v[208:223], a[48:51], a[224:227], v[208:223]
    v_exp_f32 v246, v230
    v_exp_f32 v247, v231
    v_exp_f32 v248, v232
    v_mfma_f32_32x32x16_bf16 v[208:223], a[52:55], a[228:231], v[208:223]
    v_exp_f32 v249, v233
    v_exp_f32 v250, v234
    v_exp_f32 v251, v235
    v_mfma_f32_32x32x16_bf16 v[208:223], a[56:59], a[232:235], v[208:223]
    v_exp_f32 v252, v236
    v_exp_f32 v253, v237
    v_exp_f32 v254, v238
    v_exp_f32_e64 v255, v239
    s_waitcnt vmcnt(0)
    v_pk_fma_f32 v[32:33], v[32:33], v[240:241], v[32:33]
    v_pk_fma_f32 v[34:35], v[34:35], v[242:243], v[34:35]
    v_pk_fma_f32 v[36:37], v[36:37], v[244:245], v[36:37]
    v_pk_fma_f32 v[38:39], v[38:39], v[246:247], v[38:39]
    v_pk_fma_f32 v[40:41], v[40:41], v[248:249], v[40:41]
    v_pk_fma_f32 v[42:43], v[42:43], v[250:251], v[42:43]
    v_pk_fma_f32 v[44:45], v[44:45], v[252:253], v[44:45]
    v_pk_fma_f32 v[46:47], v[46:47], v[254:255], v[46:47]
    v_pk_fma_f32 v[32:33], v[224:225], v[96:97], v[32:33]
    v_pk_fma_f32 v[34:35], v[226:227], v[98:99], v[34:35]
    v_pk_fma_f32 v[36:37], v[228:229], v[100:101], v[36:37]
    v_pk_fma_f32 v[38:39], v[230:231], v[102:103], v[38:39]
    v_pk_fma_f32 v[40:41], v[232:233], v[104:105], v[40:41]
    v_pk_fma_f32 v[42:43], v[234:235], v[106:107], v[42:43]
    v_pk_fma_f32 v[44:45], v[236:237], v[108:109], v[44:45]
    v_pk_fma_f32 v[46:47], v[238:239], v[110:111], v[46:47]
    v_pk_fma_f32 v[96:97], v[96:97], v[240:241], v[96:97]
    v_pk_fma_f32 v[98:99], v[98:99], v[242:243], v[98:99]
    v_pk_fma_f32 v[100:101], v[100:101], v[244:245], v[100:101]
    v_pk_fma_f32 v[102:103], v[102:103], v[246:247], v[102:103]
    v_pk_fma_f32 v[104:105], v[104:105], v[248:249], v[104:105]
    v_pk_fma_f32 v[106:107], v[106:107], v[250:251], v[106:107]
    v_pk_fma_f32 v[108:109], v[108:109], v[252:253], v[108:109]
    v_pk_fma_f32 v[110:111], v[110:111], v[254:255], v[110:111]
    v_mfma_f32_32x32x16_bf16 v[224:239], a[60:63], a[216:219], v[192:207]
    s_mov_b64 exec, -1
    ds_read_b128 a[216:219], v12 offset:0
    v_exp_f32 v240, v208
    v_exp_f32 v241, v209
    v_exp_f32 v242, v210
    v_mfma_f32_32x32x16_bf16 v[224:239], a[64:67], a[220:223], v[224:239]
    ds_read_b128 a[220:223], v12 offset:32
    v_exp_f32 v243, v211
    v_exp_f32 v244, v212
    v_exp_f32 v245, v213
    v_mfma_f32_32x32x16_bf16 v[224:239], a[68:71], a[224:227], v[224:239]
    ds_read_b128 a[224:227], v12 offset:64
    v_exp_f32 v246, v214
    v_exp_f32 v247, v215
    v_exp_f32 v248, v216
    v_mfma_f32_32x32x16_bf16 v[224:239], a[72:75], a[228:231], v[224:239]
    ds_read_b128 a[228:231], v12 offset:96
    v_exp_f32 v249, v217
    v_exp_f32 v250, v218
    v_exp_f32 v251, v219
    v_mfma_f32_32x32x16_bf16 v[224:239], a[76:79], a[232:235], v[224:239]
    s_waitcnt lgkmcnt(2)
    ds_read_b128 a[232:235], v13 offset:4224
    v_exp_f32 v252, v220
    v_exp_f32 v253, v221
    v_exp_f32 v254, v222
    v_exp_f32_e64 v255, v223
    s_mov_b64 exec, s[42:43]
    v_pk_fma_f32 v[48:49], v[48:49], v[240:241], v[48:49]
    v_pk_fma_f32 v[50:51], v[50:51], v[242:243], v[50:51]
    v_pk_fma_f32 v[52:53], v[52:53], v[244:245], v[52:53]
    v_pk_fma_f32 v[54:55], v[54:55], v[246:247], v[54:55]
    v_pk_fma_f32 v[56:57], v[56:57], v[248:249], v[56:57]
    v_pk_fma_f32 v[58:59], v[58:59], v[250:251], v[58:59]
    v_pk_fma_f32 v[60:61], v[60:61], v[252:253], v[60:61]
    v_pk_fma_f32 v[62:63], v[62:63], v[254:255], v[62:63]
    v_pk_fma_f32 v[48:49], v[208:209], v[112:113], v[48:49]
    v_pk_fma_f32 v[50:51], v[210:211], v[114:115], v[50:51]
    v_pk_fma_f32 v[52:53], v[212:213], v[116:117], v[52:53]
    v_pk_fma_f32 v[54:55], v[214:215], v[118:119], v[54:55]
    v_pk_fma_f32 v[56:57], v[216:217], v[120:121], v[56:57]
    v_pk_fma_f32 v[58:59], v[218:219], v[122:123], v[58:59]
    v_pk_fma_f32 v[60:61], v[220:221], v[124:125], v[60:61]
    v_pk_fma_f32 v[62:63], v[222:223], v[126:127], v[62:63]
    v_pk_fma_f32 v[112:113], v[112:113], v[240:241], v[112:113]
    v_pk_fma_f32 v[114:115], v[114:115], v[242:243], v[114:115]
    v_pk_fma_f32 v[116:117], v[116:117], v[244:245], v[116:117]
    v_pk_fma_f32 v[118:119], v[118:119], v[246:247], v[118:119]
    v_pk_fma_f32 v[120:121], v[120:121], v[248:249], v[120:121]
    v_pk_fma_f32 v[122:123], v[122:123], v[250:251], v[122:123]
    v_pk_fma_f32 v[124:125], v[124:125], v[252:253], v[124:125]
    v_pk_fma_f32 v[126:127], v[126:127], v[254:255], v[126:127]
    v_mfma_f32_32x32x16_bf16 v[208:223], a[0:3], a[216:219], v[144:159]
    s_mov_b64 exec, -1
    buffer_load_dwordx4 v[2:3], s[8:11], s33 idxen offen offset:0 lds
    buffer_load_dwordx4 v[4:5], s[8:11], s34 idxen offen offset:1056 lds
    v_exp_f32 v240, v224
    v_exp_f32 v241, v225
    v_exp_f32 v242, v226
    v_mfma_f32_32x32x16_bf16 v[208:223], a[4:7], a[220:223], v[208:223]
    s_waitcnt lgkmcnt(0)
    buffer_load_dwordx4 v[6:7], s[8:11], s35 idxen offen offset:2112 lds
    buffer_load_dwordx4 v[8:9], s[8:11], 0 idxen offen offset:3168 lds
    v_exp_f32 v243, v227
    v_exp_f32 v244, v228
    v_exp_f32 v245, v229
    v_mfma_f32_32x32x16_bf16 v[208:223], a[8:11], a[224:227], v[208:223]
    s_mov_b32 m0, s67
    v_add_u32 v1, 512, v1
    v_add_u32 v0, 512, v0
    v_exp_f32 v246, v230
    v_exp_f32 v247, v231
    v_exp_f32 v248, v232
    v_mfma_f32_32x32x16_bf16 v[208:223], a[12:15], a[228:231], v[208:223]
    buffer_load_dwordx4 v[10:11], s[12:15], 0 idxen offen lds
    v_exp_f32 v249, v233
    v_exp_f32 v250, v234
    v_exp_f32 v251, v235
    v_mfma_f32_32x32x16_bf16 v[208:223], a[16:19], a[232:235], v[208:223]
    s_mov_b64 exec, s[42:43]
    v_exp_f32 v252, v236
    v_exp_f32 v253, v237
    v_exp_f32 v254, v238
    v_exp_f32_e64 v255, v239
    s_mov_b32 m0, s36
    v_pk_fma_f32 v[64:65], v[64:65], v[240:241], v[64:65]
    v_pk_fma_f32 v[66:67], v[66:67], v[242:243], v[66:67]
    v_pk_fma_f32 v[68:69], v[68:69], v[244:245], v[68:69]
    v_pk_fma_f32 v[70:71], v[70:71], v[246:247], v[70:71]
    v_pk_fma_f32 v[72:73], v[72:73], v[248:249], v[72:73]
    v_pk_fma_f32 v[74:75], v[74:75], v[250:251], v[74:75]
    v_pk_fma_f32 v[76:77], v[76:77], v[252:253], v[76:77]
    v_pk_fma_f32 v[78:79], v[78:79], v[254:255], v[78:79]
    v_pk_fma_f32 v[64:65], v[224:225], v[128:129], v[64:65]
    v_pk_fma_f32 v[66:67], v[226:227], v[130:131], v[66:67]
    v_pk_fma_f32 v[68:69], v[228:229], v[132:133], v[68:69]
    v_pk_fma_f32 v[70:71], v[230:231], v[134:135], v[70:71]
    v_pk_fma_f32 v[72:73], v[232:233], v[136:137], v[72:73]
    v_pk_fma_f32 v[74:75], v[234:235], v[138:139], v[74:75]
    v_pk_fma_f32 v[76:77], v[236:237], v[140:141], v[76:77]
    v_pk_fma_f32 v[78:79], v[238:239], v[142:143], v[78:79]
    v_pk_fma_f32 v[128:129], v[128:129], v[240:241], v[128:129]
    v_pk_fma_f32 v[130:131], v[130:131], v[242:243], v[130:131]
    v_pk_fma_f32 v[132:133], v[132:133], v[244:245], v[132:133]
    v_pk_fma_f32 v[134:135], v[134:135], v[246:247], v[134:135]
    v_pk_fma_f32 v[136:137], v[136:137], v[248:249], v[136:137]
    v_pk_fma_f32 v[138:139], v[138:139], v[250:251], v[138:139]
    v_pk_fma_f32 v[140:141], v[140:141], v[252:253], v[140:141]
    v_pk_fma_f32 v[142:143], v[142:143], v[254:255], v[142:143]
    v_mfma_f32_32x32x16_bf16 v[224:239], a[20:23], a[216:219], v[160:175]
    s_cbranch_scc1 k2_fin
k2_lm0:
    s_mov_b64 exec, -1
    ds_read_u16 v2, v1 offset:512
    ds_read_u16 v4, v1 offset:544
    v_exp_f32 v240, v208
    v_exp_f32 v241, v209
    v_exp_f32 v242, v210
    v_mfma_f32_32x32x16_bf16 v[224:239], a[24:27], a[220:223], v[224:239]
    s_add_u32 s38, s38, 0x01000000
    v_cmp_le_u32 s[42:43], s38, v14
    v_exp_f32 v243, v211
    v_exp_f32 v244, v212
    v_exp_f32 v245, v213
    v_mfma_f32_32x32x16_bf16 v[224:239], a[28:31], a[224:227], v[224:239]
    s_cmp_eq_u32 s38, s39
    ds_read_u16 v6, v1 offset:576
    ds_read_u16 v8, v1 offset:608
    v_exp_f32 v246, v214
    v_exp_f32 v247, v215
    v_exp_f32 v248, v216
    v_mfma_f32_32x32x16_bf16 v[224:239], a[32:35], a[228:231], v[224:239]
    ds_read_b32 v10, v0 offset:516
    v_exp_f32 v249, v217
    v_exp_f32 v250, v218
    v_exp_f32 v251, v219
    v_mfma_f32_32x32x16_bf16 v[224:239], a[36:39], a[232:235], v[224:239]
    s_mov_b64 exec, s[42:43]
    v_exp_f32 v252, v220
    v_exp_f32 v253, v221
    v_exp_f32 v254, v222
    v_exp_f32 v255, v223
    v_pk_fma_f32 v[16:17], v[16:17], v[240:241], v[16:17]
    v_pk_fma_f32 v[18:19], v[18:19], v[242:243], v[18:19]
    v_pk_fma_f32 v[20:21], v[20:21], v[244:245], v[20:21]
    v_pk_fma_f32 v[22:23], v[22:23], v[246:247], v[22:23]
    v_pk_fma_f32 v[24:25], v[24:25], v[248:249], v[24:25]
    v_pk_fma_f32 v[26:27], v[26:27], v[250:251], v[26:27]
    v_pk_fma_f32 v[28:29], v[28:29], v[252:253], v[28:29]
    v_pk_fma_f32 v[30:31], v[30:31], v[254:255], v[30:31]
    v_pk_fma_f32 v[16:17], v[208:209], v[80:81], v[16:17]
    v_pk_fma_f32 v[18:19], v[210:211], v[82:83], v[18:19]
    v_pk_fma_f32 v[20:21], v[212:213], v[84:85], v[20:21]
    v_pk_fma_f32 v[22:23], v[214:215], v[86:87], v[22:23]
    v_pk_fma_f32 v[24:25], v[216:217], v[88:89], v[24:25]
    v_pk_fma_f32 v[26:27], v[218:219], v[90:91], v[26:27]
    v_pk_fma_f32 v[28:29], v[220:221], v[92:93], v[28:29]
    v_pk_fma_f32 v[30:31], v[222:223], v[94:95], v[30:31]
    v_pk_fma_f32 v[80:81], v[80:81], v[240:241], v[80:81]
    v_pk_fma_f32 v[82:83], v[82:83], v[242:243], v[82:83]
    v_pk_fma_f32 v[84:85], v[84:85], v[244:245], v[84:85]
    v_pk_fma_f32 v[86:87], v[86:87], v[246:247], v[86:87]
    v_pk_fma_f32 v[88:89], v[88:89], v[248:249], v[88:89]
    v_pk_fma_f32 v[90:91], v[90:91], v[250:251], v[90:91]
    v_pk_fma_f32 v[92:93], v[92:93], v[252:253], v[92:93]
    v_pk_fma_f32 v[94:95], v[94:95], v[254:255], v[94:95]
    v_mfma_f32_32x32x16_bf16 v[208:223], a[40:43], a[216:219], v[176:191]
    v_exp_f32 v240, v224
    v_exp_f32 v241, v225
    v_exp_f32 v242, v226
    v_mfma_f32_32x32x16_bf16 v[208:223], a[44:47], a[220:223], v[208:223]
    v_exp_f32 v243, v227
    v_exp_f32 v244, v228
    v_exp_f32 v245, v229
    v_mfma_f32_32x32x16_bf16 v[208:223], a[48:51], a[224:227], v[208:223]
    v_exp_f32 v246, v230
    v_exp_f32 v247, v231
    v_exp_f32 v248, v232
    v_mfma_f32_32x32x16_bf16 v[208:223], a[52:55], a[228:231], v[208:223]
    v_exp_f32 v249, v233
    v_exp_f32 v250, v234
    v_exp_f32 v251, v235
    v_mfma_f32_32x32x16_bf16 v[208:223], a[56:59], a[232:235], v[208:223]
    v_exp_f32 v252, v236
    v_exp_f32 v253, v237
    v_exp_f32 v254, v238
    v_exp_f32_e64 v255, v239
    s_waitcnt vmcnt(0)
    v_pk_fma_f32 v[32:33], v[32:33], v[240:241], v[32:33]
    v_pk_fma_f32 v[34:35], v[34:35], v[242:243], v[34:35]
    v_pk_fma_f32 v[36:37], v[36:37], v[244:245], v[36:37]
    v_pk_fma_f32 v[38:39], v[38:39], v[246:247], v[38:39]
    v_pk_fma_f32 v[40:41], v[40:41], v[248:249], v[40:41]
    v_pk_fma_f32 v[42:43], v[42:43], v[250:251], v[42:43]
    v_pk_fma_f32 v[44:45], v[44:45], v[252:253], v[44:45]
    v_pk_fma_f32 v[46:47], v[46:47], v[254:255], v[46:47]
    v_pk_fma_f32 v[32:33], v[224:225], v[96:97], v[32:33]
    v_pk_fma_f32 v[34:35], v[226:227], v[98:99], v[34:35]
    v_pk_fma_f32 v[36:37], v[228:229], v[100:101], v[36:37]
    v_pk_fma_f32 v[38:39], v[230:231], v[102:103], v[38:39]
    v_pk_fma_f32 v[40:41], v[232:233], v[104:105], v[40:41]
    v_pk_fma_f32 v[42:43], v[234:235], v[106:107], v[42:43]
    v_pk_fma_f32 v[44:45], v[236:237], v[108:109], v[44:45]
    v_pk_fma_f32 v[46:47], v[238:239], v[110:111], v[46:47]
    v_pk_fma_f32 v[96:97], v[96:97], v[240:241], v[96:97]
    v_pk_fma_f32 v[98:99], v[98:99], v[242:243], v[98:99]
    v_pk_fma_f32 v[100:101], v[100:101], v[244:245], v[100:101]
    v_pk_fma_f32 v[102:103], v[102:103], v[246:247], v[102:103]
    v_pk_fma_f32 v[104:105], v[104:105], v[248:249], v[104:105]
    v_pk_fma_f32 v[106:107], v[106:107], v[250:251], v[106:107]
    v_pk_fma_f32 v[108:109], v[108:109], v[252:253], v[108:109]
    v_pk_fma_f32 v[110:111], v[110:111], v[254:255], v[110:111]
    v_mfma_f32_32x32x16_bf16 v[224:239], a[60:63], a[216:219], v[192:207]
    s_mov_b64 exec, -1
    ds_read_b128 a[216:219], v12 offset:5248
    v_exp_f32 v240, v208
    v_exp_f32 v241, v209
    v_exp_f32 v242, v210
    v_mfma_f32_32x32x16_bf16 v[224:239], a[64:67], a[220:223], v[224:239]
    ds_read_b128 a[220:223], v12 offset:5280
    v_exp_f32 v243, v211
    v_exp_f32 v244, v212
    v_exp_f32 v245, v213
    v_mfma_f32_32x32x16_bf16 v[224:239], a[68:71], a[224:227], v[224:239]
    ds_read_b128 a[224:227], v12 offset:5312
    v_exp_f32 v246, v214
    v_exp_f32 v247, v215
    v_exp_f32 v248, v216
    v_mfma_f32_32x32x16_bf16 v[224:239], a[72:75], a[228:231], v[224:239]
    ds_read_b128 a[228:231], v12 offset:5344
    v_exp_f32 v249, v217
    v_exp_f32 v250, v218
    v_exp_f32 v251, v219
    v_mfma_f32_32x32x16_bf16 v[224:239], a[76:79], a[232:235], v[224:239]
    s_waitcnt lgkmcnt(2)
    ds_read_b128 a[232:235], v13 offset:9472
    v_exp_f32 v252, v220
    v_exp_f32 v253, v221
    v_exp_f32 v254, v222
    v_exp_f32_e64 v255, v223
    s_mov_b64 exec, s[42:43]
    v_pk_fma_f32 v[48:49], v[48:49], v[240:241], v[48:49]
    v_pk_fma_f32 v[50:51], v[50:51], v[242:243], v[50:51]
    v_pk_fma_f32 v[52:53], v[52:53], v[244:245], v[52:53]
    v_pk_fma_f32 v[54:55], v[54:55], v[246:247], v[54:55]
    v_pk_fma_f32 v[56:57], v[56:57], v[248:249], v[56:57]
    v_pk_fma_f32 v[58:59], v[58:59], v[250:251], v[58:59]
    v_pk_fma_f32 v[60:61], v[60:61], v[252:253], v[60:61]
    v_pk_fma_f32 v[62:63], v[62:63], v[254:255], v[62:63]
    v_pk_fma_f32 v[48:49], v[208:209], v[112:113], v[48:49]
    v_pk_fma_f32 v[50:51], v[210:211], v[114:115], v[50:51]
    v_pk_fma_f32 v[52:53], v[212:213], v[116:117], v[52:53]
    v_pk_fma_f32 v[54:55], v[214:215], v[118:119], v[54:55]
    v_pk_fma_f32 v[56:57], v[216:217], v[120:121], v[56:57]
    v_pk_fma_f32 v[58:59], v[218:219], v[122:123], v[58:59]
    v_pk_fma_f32 v[60:61], v[220:221], v[124:125], v[60:61]
    v_pk_fma_f32 v[62:63], v[222:223], v[126:127], v[62:63]
    v_pk_fma_f32 v[112:113], v[112:113], v[240:241], v[112:113]
    v_pk_fma_f32 v[114:115], v[114:115], v[242:243], v[114:115]
    v_pk_fma_f32 v[116:117], v[116:117], v[244:245], v[116:117]
    v_pk_fma_f32 v[118:119], v[118:119], v[246:247], v[118:119]
    v_pk_fma_f32 v[120:121], v[120:121], v[248:249], v[120:121]
    v_pk_fma_f32 v[122:123], v[122:123], v[250:251], v[122:123]
    v_pk_fma_f32 v[124:125], v[124:125], v[252:253], v[124:125]
    v_pk_fma_f32 v[126:127], v[126:127], v[254:255], v[126:127]
    v_mfma_f32_32x32x16_bf16 v[208:223], a[0:3], a[216:219], v[144:159]
    s_mov_b64 exec, -1
    buffer_load_dwordx4 v[2:3], s[8:11], s33 idxen offen offset:0 lds
    buffer_load_dwordx4 v[4:5], s[8:11], s34 idxen offen offset:1056 lds
    v_exp_f32 v240, v224
    v_exp_f32 v241, v225
    v_exp_f32 v242, v226
    v_mfma_f32_32x32x16_bf16 v[208:223], a[4:7], a[220:223], v[208:223]
    s_waitcnt lgkmcnt(0)
    buffer_load_dwordx4 v[6:7], s[8:11], s35 idxen offen offset:2112 lds
    buffer_load_dwordx4 v[8:9], s[8:11], 0 idxen offen offset:3168 lds
    v_exp_f32 v243, v227
    v_exp_f32 v244, v228
    v_exp_f32 v245, v229
    v_mfma_f32_32x32x16_bf16 v[208:223], a[8:11], a[224:227], v[208:223]
    s_mov_b32 m0, s66
    v_exp_f32 v246, v230
    v_exp_f32 v247, v231
    v_exp_f32 v248, v232
    v_mfma_f32_32x32x16_bf16 v[208:223], a[12:15], a[228:231], v[208:223]
    buffer_load_dwordx4 v[10:11], s[12:15], 0 idxen offen lds
    v_exp_f32 v249, v233
    v_exp_f32 v250, v234
    v_exp_f32 v251, v235
    v_mfma_f32_32x32x16_bf16 v[208:223], a[16:19], a[232:235], v[208:223]
    s_mov_b64 exec, s[42:43]
    v_exp_f32 v252, v236
    v_exp_f32 v253, v237
    v_exp_f32 v254, v238
    v_exp_f32_e64 v255, v239
    s_mov_b32 m0, s65
    v_pk_fma_f32 v[64:65], v[64:65], v[240:241], v[64:65]
    v_pk_fma_f32 v[66:67], v[66:67], v[242:243], v[66:67]
    v_pk_fma_f32 v[68:69], v[68:69], v[244:245], v[68:69]
    v_pk_fma_f32 v[70:71], v[70:71], v[246:247], v[70:71]
    v_pk_fma_f32 v[72:73], v[72:73], v[248:249], v[72:73]
    v_pk_fma_f32 v[74:75], v[74:75], v[250:251], v[74:75]
    v_pk_fma_f32 v[76:77], v[76:77], v[252:253], v[76:77]
    v_pk_fma_f32 v[78:79], v[78:79], v[254:255], v[78:79]
    v_pk_fma_f32 v[64:65], v[224:225], v[128:129], v[64:65]
    v_pk_fma_f32 v[66:67], v[226:227], v[130:131], v[66:67]
    v_pk_fma_f32 v[68:69], v[228:229], v[132:133], v[68:69]
    v_pk_fma_f32 v[70:71], v[230:231], v[134:135], v[70:71]
    v_pk_fma_f32 v[72:73], v[232:233], v[136:137], v[72:73]
    v_pk_fma_f32 v[74:75], v[234:235], v[138:139], v[74:75]
    v_pk_fma_f32 v[76:77], v[236:237], v[140:141], v[76:77]
    v_pk_fma_f32 v[78:79], v[238:239], v[142:143], v[78:79]
    v_pk_fma_f32 v[128:129], v[128:129], v[240:241], v[128:129]
    v_pk_fma_f32 v[130:131], v[130:131], v[242:243], v[130:131]
    v_pk_fma_f32 v[132:133], v[132:133], v[244:245], v[132:133]
    v_pk_fma_f32 v[134:135], v[134:135], v[246:247], v[134:135]
    v_pk_fma_f32 v[136:137], v[136:137], v[248:249], v[136:137]
    v_pk_fma_f32 v[138:139], v[138:139], v[250:251], v[138:139]
    v_pk_fma_f32 v[140:141], v[140:141], v[252:253], v[140:141]
    v_pk_fma_f32 v[142:143], v[142:143], v[254:255], v[142:143]
    v_mfma_f32_32x32x16_bf16 v[224:239], a[20:23], a[216:219], v[160:175]
    s_cbranch_scc0 k2_lm1
k2_fin:
    s_mov_b64 exec, -1
    v_cvt_f32_ubyte3 v248, v14
    v_mov_b32 v249, 0
    v_mov_b32 v250, 0
    v_cvt_pk_bf16_f32 v248, v248, v248
    v_mov_b32 v251, 0
    v_max_f32 v15, v80, v81
    v_max3_f32 v15, v82, v83, v15
    v_mfma_f32_32x32x16_bf16 v[208:223], a[208:211], v[248:251], 0
    v_max3_f32 v15, v84, v85, v15
    v_max3_f32 v15, v86, v87, v15
    v_max3_f32 v15, v88, v89, v15
    v_max3_f32 v15, v90, v91, v15
    v_max3_f32 v15, v92, v93, v15
    v_max3_f32 v15, v94, v95, v15
    v_rcp_f32 v80, v80
    v_rcp_f32 v81, v81
    v_rcp_f32 v82, v82
    v_rcp_f32 v83, v83
    v_mfma_f32_32x32x16_bf16 v[224:239], a[212:215], v[248:251], 0
    v_rcp_f32 v84, v84
    v_rcp_f32 v85, v85
    v_rcp_f32 v86, v86
    v_rcp_f32 v87, v87
    v_rcp_f32 v88, v88
    v_rcp_f32 v89, v89
    v_rcp_f32 v90, v90
    v_rcp_f32 v91, v91
    v_rcp_f32 v92, v92
    v_rcp_f32 v93, v93
    v_rcp_f32 v94, v94
    v_rcp_f32_e64 v95, v95
    v_pk_mul_f32 v[16:17], v[16:17], v[80:81]
    v_pk_mul_f32 v[18:19], v[18:19], v[82:83]
    v_pk_mul_f32 v[20:21], v[20:21], v[84:85]
    v_pk_mul_f32 v[22:23], v[22:23], v[86:87]
    v_pk_mul_f32 v[24:25], v[24:25], v[88:89]
    v_pk_mul_f32 v[26:27], v[26:27], v[90:91]
    v_pk_mul_f32 v[28:29], v[28:29], v[92:93]
    v_pk_mul_f32 v[30:31], v[30:31], v[94:95]
    v_cvt_pk_bf16_f32 v240, v16, v17
    v_cvt_pk_bf16_f32 v241, v18, v19
    v_cvt_pk_bf16_f32 v242, v20, v21
    v_cvt_pk_bf16_f32 v243, v22, v23
    v_cvt_pk_bf16_f32 v244, v24, v25
    v_cvt_pk_bf16_f32 v245, v26, v27
    v_cvt_pk_bf16_f32 v246, v28, v29
    v_cvt_pk_bf16_f32 v247, v30, v31
    v_max3_f32 v15, v96, v97, v15
    v_max3_f32 v15, v98, v99, v15
    v_mfma_f32_32x32x16_bf16 v[208:223], a[144:147], v[240:243], v[208:223]
    v_max3_f32 v15, v100, v101, v15
    v_max3_f32 v15, v102, v103, v15
    v_max3_f32 v15, v104, v105, v15
    v_max3_f32 v15, v106, v107, v15
    v_max3_f32 v15, v108, v109, v15
    v_max3_f32 v15, v110, v111, v15
    v_rcp_f32 v96, v96
    v_mfma_f32_32x32x16_bf16 v[224:239], a[148:151], v[240:243], v[224:239]
    v_rcp_f32 v97, v97
    v_rcp_f32 v98, v98
    v_rcp_f32 v99, v99
    v_mfma_f32_32x32x16_bf16 v[208:223], a[152:155], v[244:247], v[208:223]
    v_rcp_f32 v100, v100
    v_rcp_f32 v101, v101
    v_rcp_f32 v102, v102
    v_mfma_f32_32x32x16_bf16 v[224:239], a[156:159], v[244:247], v[224:239]
    v_rcp_f32 v103, v103
    v_rcp_f32 v104, v104
    v_rcp_f32 v105, v105
    v_rcp_f32 v106, v106
    v_rcp_f32 v107, v107
    v_rcp_f32 v108, v108
    v_rcp_f32 v109, v109
    v_rcp_f32 v110, v110
    v_rcp_f32 v111, v111
    v_pk_mul_f32 v[32:33], v[32:33], v[96:97]
    v_pk_mul_f32 v[34:35], v[34:35], v[98:99]
    v_pk_mul_f32 v[36:37], v[36:37], v[100:101]
    v_pk_mul_f32 v[38:39], v[38:39], v[102:103]
    v_pk_mul_f32 v[40:41], v[40:41], v[104:105]
    v_pk_mul_f32 v[42:43], v[42:43], v[106:107]
    v_pk_mul_f32 v[44:45], v[44:45], v[108:109]
    v_pk_mul_f32 v[46:47], v[46:47], v[110:111]
    v_cvt_pk_bf16_f32 v248, v32, v33
    v_cvt_pk_bf16_f32 v249, v34, v35
    v_cvt_pk_bf16_f32 v250, v36, v37
    v_cvt_pk_bf16_f32 v251, v38, v39
    v_cvt_pk_bf16_f32 v252, v40, v41
    v_cvt_pk_bf16_f32 v253, v42, v43
    v_cvt_pk_bf16_f32 v254, v44, v45
    v_cvt_pk_bf16_f32 v255, v46, v47
    v_max3_f32 v15, v112, v113, v15
    v_max3_f32 v15, v114, v115, v15
    v_mfma_f32_32x32x16_bf16 v[208:223], a[160:163], v[248:251], v[208:223]
    v_max3_f32 v15, v116, v117, v15
    v_max3_f32 v15, v118, v119, v15
    v_max3_f32 v15, v120, v121, v15
    v_max3_f32 v15, v122, v123, v15
    v_max3_f32 v15, v124, v125, v15
    v_max3_f32 v15, v126, v127, v15
    v_rcp_f32 v112, v112
    v_mfma_f32_32x32x16_bf16 v[224:239], a[164:167], v[248:251], v[224:239]
    v_rcp_f32 v113, v113
    v_rcp_f32 v114, v114
    v_rcp_f32 v115, v115
    v_mfma_f32_32x32x16_bf16 v[208:223], a[168:171], v[252:255], v[208:223]
    v_rcp_f32 v116, v116
    v_rcp_f32 v117, v117
    v_rcp_f32 v118, v118
    v_mfma_f32_32x32x16_bf16 v[224:239], a[172:175], v[252:255], v[224:239]
    v_rcp_f32 v119, v119
    v_rcp_f32 v120, v120
    v_rcp_f32 v121, v121
    v_rcp_f32 v122, v122
    v_rcp_f32 v123, v123
    v_rcp_f32 v124, v124
    v_rcp_f32 v125, v125
    v_rcp_f32 v126, v126
    v_rcp_f32 v127, v127
    v_pk_mul_f32 v[48:49], v[48:49], v[112:113]
    v_pk_mul_f32 v[50:51], v[50:51], v[114:115]
    v_pk_mul_f32 v[52:53], v[52:53], v[116:117]
    v_pk_mul_f32 v[54:55], v[54:55], v[118:119]
    v_pk_mul_f32 v[56:57], v[56:57], v[120:121]
    v_pk_mul_f32 v[58:59], v[58:59], v[122:123]
    v_pk_mul_f32 v[60:61], v[60:61], v[124:125]
    v_pk_mul_f32 v[62:63], v[62:63], v[126:127]
    v_cvt_pk_bf16_f32 v240, v48, v49
    v_cvt_pk_bf16_f32 v241, v50, v51
    v_cvt_pk_bf16_f32 v242, v52, v53
    v_cvt_pk_bf16_f32 v243, v54, v55
    v_cvt_pk_bf16_f32 v244, v56, v57
    v_cvt_pk_bf16_f32 v245, v58, v59
    v_cvt_pk_bf16_f32 v246, v60, v61
    v_cvt_pk_bf16_f32 v247, v62, v63
    v_max3_f32 v15, v128, v129, v15
    v_max3_f32 v15, v130, v131, v15
    v_mfma_f32_32x32x16_bf16 v[208:223], a[176:179], v[240:243], v[208:223]
    v_max3_f32 v15, v132, v133, v15
    v_max3_f32 v15, v134, v135, v15
    v_max3_f32 v15, v136, v137, v15
    v_max3_f32 v15, v138, v139, v15
    v_max3_f32 v15, v140, v141, v15
    v_max3_f32 v15, v142, v143, v15
    v_rcp_f32 v128, v128
    v_mfma_f32_32x32x16_bf16 v[224:239], a[180:183], v[240:243], v[224:239]
    v_rcp_f32 v129, v129
    v_rcp_f32 v130, v130
    v_rcp_f32 v131, v131
    v_mfma_f32_32x32x16_bf16 v[208:223], a[184:187], v[244:247], v[208:223]
    v_rcp_f32 v132, v132
    v_rcp_f32 v133, v133
    v_rcp_f32 v134, v134
    v_mfma_f32_32x32x16_bf16 v[224:239], a[188:191], v[244:247], v[224:239]
    v_rcp_f32 v135, v135
    v_rcp_f32 v136, v136
    v_rcp_f32 v137, v137
    v_rcp_f32 v138, v138
    v_rcp_f32 v139, v139
    v_rcp_f32 v140, v140
    v_rcp_f32 v141, v141
    v_rcp_f32 v142, v142
    v_rcp_f32 v143, v143
    v_pk_mul_f32 v[64:65], v[64:65], v[128:129]
    v_pk_mul_f32 v[66:67], v[66:67], v[130:131]
    v_pk_mul_f32 v[68:69], v[68:69], v[132:133]
    v_pk_mul_f32 v[70:71], v[70:71], v[134:135]
    v_pk_mul_f32 v[72:73], v[72:73], v[136:137]
    v_pk_mul_f32 v[74:75], v[74:75], v[138:139]
    v_pk_mul_f32 v[76:77], v[76:77], v[140:141]
    v_pk_mul_f32 v[78:79], v[78:79], v[142:143]
    v_cvt_pk_bf16_f32 v248, v64, v65
    v_cvt_pk_bf16_f32 v249, v66, v67
    v_cvt_pk_bf16_f32 v250, v68, v69
    v_cvt_pk_bf16_f32 v251, v70, v71
    v_cvt_pk_bf16_f32 v252, v72, v73
    v_cvt_pk_bf16_f32 v253, v74, v75
    v_cvt_pk_bf16_f32 v254, v76, v77
    v_cvt_pk_bf16_f32 v255, v78, v79
    v_cmp_le_f32 s[46:47], s48, v15
    v_bfe_u32 v15, v14, 16, 2
    v_mfma_f32_32x32x16_bf16 v[208:223], a[192:195], v[248:251], v[208:223]
    v_cmp_ne_u32 s[40:41], 0, v15
    v_mov_b32 v128, 0x207
    v_accvgpr_read_b32 v15, a238
    v_accvgpr_read_b32 v129, a241
    v_accvgpr_read_b32 v132, a246
    v_accvgpr_read_b32 v133, a247
    v_accvgpr_read_b32 v134, a248
    v_accvgpr_read_b32 v135, a249
    v_mfma_f32_32x32x16_bf16 v[224:239], a[196:199], v[248:251], v[224:239]
    s_or_b64 s[52:53], s[52:53], s[46:47]
    v_mfma_f32_32x32x16_bf16 v[208:223], a[200:203], v[252:255], v[208:223]
    v_mfma_f32_32x32x16_bf16 v[224:239], a[204:207], v[252:255], v[224:239]
    s_nop 10
    s_nop 0
    s_nop 0
    v_pk_mul_f32 v[208:209], v[208:209], s[44:45]
    v_pk_mul_f32 v[210:211], v[210:211], s[44:45]
    v_pk_mul_f32 v[212:213], v[212:213], s[44:45]
    v_pk_mul_f32 v[214:215], v[214:215], s[44:45]
    v_pk_mul_f32 v[216:217], v[216:217], s[44:45]
    v_pk_mul_f32 v[218:219], v[218:219], s[44:45]
    v_pk_mul_f32 v[220:221], v[220:221], s[44:45]
    v_pk_mul_f32 v[222:223], v[222:223], s[44:45]
    v_pk_mul_f32 v[224:225], v[224:225], s[44:45]
    v_pk_mul_f32 v[226:227], v[226:227], s[44:45]
    v_pk_mul_f32 v[228:229], v[228:229], s[44:45]
    v_pk_mul_f32 v[230:231], v[230:231], s[44:45]
    v_pk_mul_f32 v[232:233], v[232:233], s[44:45]
    v_pk_mul_f32 v[234:235], v[234:235], s[44:45]
    v_pk_mul_f32 v[236:237], v[236:237], s[44:45]
    v_pk_mul_f32 v[238:239], v[238:239], s[44:45]
    v_cmp_class_f32 s[46:47], v208, v128
    s_mov_b64 exec, s[40:41]
    s_cbranch_execz k2_nosplit
    v_add_f32_dpp v208, v208, v208 quad_perm:[1,0,3,2] row_mask:0xf bank_mask:0xf
    v_add_f32_dpp v209, v209, v209 quad_perm:[1,0,3,2] row_mask:0xf bank_mask:0xf
    v_add_f32_dpp v210, v210, v210 quad_perm:[1,0,3,2] row_mask:0xf bank_mask:0xf
    v_add_f32_dpp v211, v211, v211 quad_perm:[1,0,3,2] row_mask:0xf bank_mask:0xf
    v_add_f32_dpp v212, v212, v212 quad_perm:[1,0,3,2] row_mask:0xf bank_mask:0xf
    v_add_f32_dpp v213, v213, v213 quad_perm:[1,0,3,2] row_mask:0xf bank_mask:0xf
    v_add_f32_dpp v214, v214, v214 quad_perm:[1,0,3,2] row_mask:0xf bank_mask:0xf
    v_add_f32_dpp v215, v215, v215 quad_perm:[1,0,3,2] row_mask:0xf bank_mask:0xf
    v_add_f32_dpp v216, v216, v216 quad_perm:[1,0,3,2] row_mask:0xf bank_mask:0xf
    v_add_f32_dpp v217, v217, v217 quad_perm:[1,0,3,2] row_mask:0xf bank_mask:0xf
    v_add_f32_dpp v218, v218, v218 quad_perm:[1,0,3,2] row_mask:0xf bank_mask:0xf
    v_add_f32_dpp v219, v219, v219 quad_perm:[1,0,3,2] row_mask:0xf bank_mask:0xf
    v_add_f32_dpp v220, v220, v220 quad_perm:[1,0,3,2] row_mask:0xf bank_mask:0xf
    v_add_f32_dpp v221, v221, v221 quad_perm:[1,0,3,2] row_mask:0xf bank_mask:0xf
    v_add_f32_dpp v222, v222, v222 quad_perm:[1,0,3,2] row_mask:0xf bank_mask:0xf
    v_add_f32_dpp v223, v223, v223 quad_perm:[1,0,3,2] row_mask:0xf bank_mask:0xf
    v_add_f32_dpp v224, v224, v224 quad_perm:[1,0,3,2] row_mask:0xf bank_mask:0xf
    v_add_f32_dpp v225, v225, v225 quad_perm:[1,0,3,2] row_mask:0xf bank_mask:0xf
    v_add_f32_dpp v226, v226, v226 quad_perm:[1,0,3,2] row_mask:0xf bank_mask:0xf
    v_add_f32_dpp v227, v227, v227 quad_perm:[1,0,3,2] row_mask:0xf bank_mask:0xf
    v_add_f32_dpp v228, v228, v228 quad_perm:[1,0,3,2] row_mask:0xf bank_mask:0xf
    v_add_f32_dpp v229, v229, v229 quad_perm:[1,0,3,2] row_mask:0xf bank_mask:0xf
    v_add_f32_dpp v230, v230, v230 quad_perm:[1,0,3,2] row_mask:0xf bank_mask:0xf
    v_add_f32_dpp v231, v231, v231 quad_perm:[1,0,3,2] row_mask:0xf bank_mask:0xf
    v_add_f32_dpp v232, v232, v232 quad_perm:[1,0,3,2] row_mask:0xf bank_mask:0xf
    v_add_f32_dpp v233, v233, v233 quad_perm:[1,0,3,2] row_mask:0xf bank_mask:0xf
    v_add_f32_dpp v234, v234, v234 quad_perm:[1,0,3,2] row_mask:0xf bank_mask:0xf
    v_add_f32_dpp v235, v235, v235 quad_perm:[1,0,3,2] row_mask:0xf bank_mask:0xf
    v_add_f32_dpp v236, v236, v236 quad_perm:[1,0,3,2] row_mask:0xf bank_mask:0xf
    v_add_f32_dpp v237, v237, v237 quad_perm:[1,0,3,2] row_mask:0xf bank_mask:0xf
    v_add_f32_dpp v238, v238, v238 quad_perm:[1,0,3,2] row_mask:0xf bank_mask:0xf
    v_add_f32_dpp v239, v239, v239 quad_perm:[1,0,3,2] row_mask:0xf bank_mask:0xf
k2_nosplit:
    s_mov_b64 exec, -1
    s_or_b64 s[52:53], s[52:53], s[46:47]
    v_cvt_pk_bf16_f32 v240, v208, v209
    v_cvt_pk_bf16_f32 v241, v210, v211
    v_cvt_pk_bf16_f32 v242, v212, v213
    v_cvt_pk_bf16_f32 v243, v214, v215
    v_cvt_pk_bf16_f32 v244, v216, v217
    v_cvt_pk_bf16_f32 v245, v218, v219
    v_cvt_pk_bf16_f32 v246, v220, v221
    v_cvt_pk_bf16_f32 v247, v222, v223
    v_cvt_pk_bf16_f32 v248, v224, v225
    v_cvt_pk_bf16_f32 v249, v226, v227
    v_cvt_pk_bf16_f32 v250, v228, v229
    v_cvt_pk_bf16_f32 v251, v230, v231
    v_cvt_pk_bf16_f32 v252, v232, v233
    v_cvt_pk_bf16_f32 v253, v234, v235
    v_cvt_pk_bf16_f32 v254, v236, v237
    v_cvt_pk_bf16_f32 v255, v238, v239
    ds_write_b128 v15, v[240:243] offset:0
    ds_write_b128 v15, v[244:247] offset:16
    ds_write_b128 v15, v[248:251] offset:32
    ds_write_b128 v15, v[252:255] offset:48
    ds_read_b128 v[224:227], v129 offset:0
    ds_read_b128 v[228:231], v129 offset:1152
    ds_read_b128 v[232:235], v129 offset:2304
    ds_read_b128 v[236:239], v129 offset:3456
    s_waitcnt lgkmcnt(3)
    buffer_store_dwordx4 v[224:227], v132, s[16:19], 0 offen sc1
    s_waitcnt lgkmcnt(2)
    buffer_store_dwordx4 v[228:231], v133, s[16:19], 0 offen sc1
    s_waitcnt lgkmcnt(1)
    buffer_store_dwordx4 v[232:235], v134, s[16:19], 0 offen sc1
    s_waitcnt lgkmcnt(0)
    buffer_store_dwordx4 v[236:239], v135, s[16:19], 0 offen sc1
    v_mov_b32 v20, 163648
    v_mov_b32 v21, 1
    s_mov_b64 exec, s[52:53]
    ds_write_b32 v20, v21
    s_mov_b64 exec, -1
    s_cmp_lg_u32 s28, 3
    s_cbranch_scc1 k2_nonew_a
    s_waitcnt vmcnt(4)
    v_accvgpr_read_b32 v16, a239
    v_mov_b32 v18, s99
    v_mov_b32 v19, s101
    v_readfirstlane_b32 s46, v16
    s_cmp_lg_u32 s46, 255
    s_cbranch_scc1 k2_nonew_a
    s_mov_b64 exec, 1
    buffer_store_dwordx2 v[18:19], off, s[24:27], 0 sc1
    s_mov_b64 exec, -1
k2_nonew_a:
    s_waitcnt lgkmcnt(0)
    s_barrier
    ds_read_b32 v17, v20
    s_waitcnt lgkmcnt(0)
    v_readfirstlane_b32 s47, v17
    s_cmp_lg_u32 s47, 0
    s_cbranch_scc1 k2_slow
k2_done:
    s_endpgm
k2_giveup:
    s_barrier
    s_mov_b32 s62, 2
k2_drop:
    s_mov_b64 s[52:53], -1
    s_mov_b32 s60, 4
    s_waitcnt vmcnt(0) lgkmcnt(0)
    v_mov_b32 v17, -1
    v_mov_b32 v21, -1
    v_mov_b32 v25, -1
    v_mov_b32 v29, -1
    s_branch k2_ld_done
k2_fix0:
    s_mov_b64 exec, vcc
    v_mov_b32 v16, 0
    v_mov_b32 v80, 1.0
    v_mov_b32 v17, 0
    v_mov_b32 v81, 1.0
    v_mov_b32 v18, 0
    v_mov_b32 v82, 1.0
    v_mov_b32 v19, 0
    v_mov_b32 v83, 1.0
    v_mov_b32 v20, 0
    v_mov_b32 v84, 1.0
    v_mov_b32 v21, 0
    v_mov_b32 v85, 1.0
    v_mov_b32 v22, 0
    v_mov_b32 v86, 1.0
    v_mov_b32 v23, 0
    v_mov_b32 v87, 1.0
    v_mov_b32 v24, 0
    v_mov_b32 v88, 1.0
    v_mov_b32 v25, 0
    v_mov_b32 v89, 1.0
    v_mov_b32 v26, 0
    v_mov_b32 v90, 1.0
    v_mov_b32 v27, 0
    v_mov_b32 v91, 1.0
    v_mov_b32 v28, 0
    v_mov_b32 v92, 1.0
    v_mov_b32 v29, 0
    v_mov_b32 v93, 1.0
    v_mov_b32 v30, 0
    v_mov_b32 v94, 1.0
    v_mov_b32 v31, 0
    v_mov_b32 v95, 1.0
    v_mov_b32 v32, 0
    v_mov_b32 v96, 1.0
    v_mov_b32 v33, 0
    v_mov_b32 v97, 1.0
    v_mov_b32 v34, 0
    v_mov_b32 v98, 1.0
    v_mov_b32 v35, 0
    v_mov_b32 v99, 1.0
    v_mov_b32 v36, 0
    v_mov_b32 v100, 1.0
    v_mov_b32 v37, 0
    v_mov_b32 v101, 1.0
    v_mov_b32 v38, 0
    v_mov_b32 v102, 1.0
    v_mov_b32 v39, 0
    v_mov_b32 v103, 1.0
    v_mov_b32 v40, 0
    v_mov_b32 v104, 1.0
    v_mov_b32 v41, 0
    v_mov_b32 v105, 1.0
    v_mov_b32 v42, 0
    v_mov_b32 v106, 1.0
    v_mov_b32 v43, 0
    v_mov_b32 v107, 1.0
    v_mov_b32 v44, 0
    v_mov_b32 v108, 1.0
    v_mov_b32 v45, 0
    v_mov_b32 v109, 1.0
    v_mov_b32 v46, 0
    v_mov_b32 v110, 1.0
    v_mov_b32 v47, 0
    v_mov_b32 v111, 1.0
    v_mov_b32 v48, 0
    v_mov_b32 v112, 1.0
    v_mov_b32 v49, 0
    v_mov_b32 v113, 1.0
    v_mov_b32 v50, 0
    v_mov_b32 v114, 1.0
    v_mov_b32 v51, 0
    v_mov_b32 v115, 1.0
    v_mov_b32 v52, 0
    v_mov_b32 v116, 1.0
    v_mov_b32 v53, 0
    v_mov_b32 v117, 1.0
    v_mov_b32 v54, 0
    v_mov_b32 v118, 1.0
    v_mov_b32 v55, 0
    v_mov_b32 v119, 1.0
    v_mov_b32 v56, 0
    v_mov_b32 v120, 1.0
    v_mov_b32 v57, 0
    v_mov_b32 v121, 1.0
    v_mov_b32 v58, 0
    v_mov_b32 v122, 1.0
    v_mov_b32 v59, 0
    v_mov_b32 v123, 1.0
    v_mov_b32 v60, 0
    v_mov_b32 v124, 1.0
    v_mov_b32 v61, 0
    v_mov_b32 v125, 1.0
    v_mov_b32 v62, 0
    v_mov_b32 v126, 1.0
    v_mov_b32 v63, 0
    v_mov_b32 v127, 1.0
    v_mov_b32 v64, 0
    v_mov_b32 v128, 1.0
    v_mov_b32 v65, 0
    v_mov_b32 v129, 1.0
    v_mov_b32 v66, 0
    v_mov_b32 v130, 1.0
    v_mov_b32 v67, 0
    v_mov_b32 v131, 1.0
    v_mov_b32 v68, 0
    v_mov_b32 v132, 1.0
    v_mov_b32 v69, 0
    v_mov_b32 v133, 1.0
    v_mov_b32 v70, 0
    v_mov_b32 v134, 1.0
    v_mov_b32 v71, 0
    v_mov_b32 v135, 1.0
    v_mov_b32 v72, 0
    v_mov_b32 v136, 1.0
    v_mov_b32 v73, 0
    v_mov_b32 v137, 1.0
    v_mov_b32 v74, 0
    v_mov_b32 v138, 1.0
    v_mov_b32 v75, 0
    v_mov_b32 v139, 1.0
    v_mov_b32 v76, 0
    v_mov_b32 v140, 1.0
    v_mov_b32 v77, 0
    v_mov_b32 v141, 1.0
    v_mov_b32 v78, 0
    v_mov_b32 v142, 1.0
    v_mov_b32 v79, 0
    v_mov_b32 v143, 1.0
    s_mov_b64 exec, -1
    s_branch k2_fix0_back
k2_slow_w:
    s_waitcnt lgkmcnt(0)
    s_cmp_lg_u32 s28, 3
    s_cbranch_scc1 k2_notk_b
    s_mov_b64 exec, 1
    v_mov_b32 v15, 0
    global_atomic_add a239, v15, a239, s[68:69] sc0
    s_mov_b64 exec, -1
k2_notk_b:
    s_cmp_lg_u32 s28, 3
    s_cbranch_scc1 k2_nonew_b
    s_waitcnt vmcnt(0)
    v_accvgpr_read_b32 v16, a239
    v_mov_b32 v18, s99
    v_mov_b32 v19, s101
    v_readfirstlane_b32 s46, v16
    s_cmp_lg_u32 s46, 255
    s_cbranch_scc1 k2_nonew_b
    s_mov_b64 exec, 1
    buffer_store_dwordx2 v[18:19], off, s[24:27], 0 sc1
    s_mov_b64 exec, -1
k2_nonew_b:
k2_slow:
    s_waitcnt vmcnt(0) lgkmcnt(0)
    s_barrier
    v_mbcnt_lo_u32_b32 v3, -1, 0
    v_mbcnt_hi_u32_b32 v3, -1, v3
    s_lshl_b32 s46, s28, 6
    v_add_u32 v0, s46, v3
    v_and_b32 v7, 31, v3
    v_lshrrev_b32 v8, 5, v3
    v_lshlrev_b32 v1, 4, v0
    v_mov_b32 v16, 0
    v_mov_b32 v17, 0
    v_mov_b32 v18, 0
    v_mov_b32 v19, 0
    ds_write_b128 v1, v[16:19] offset:0
    ds_write_b128 v1, v[16:19] offset:4096
    ds_write_b128 v1, v[16:19] offset:8192
    ds_write_b128 v1, v[16:19] offset:12288
    ds_write_b128 v1, v[16:19] offset:16384
    ds_write_b128 v1, v[16:19] offset:20480
    ds_write_b128 v1, v[16:19] offset:24576
    ds_write_b128 v1, v[16:19] offset:28672
    ds_write_b128 v1, v[16:19] offset:32768
    ds_write_b128 v1, v[16:19] offset:36864
    ds_write_b128 v1, v[16:19] offset:40960
    ds_write_b128 v1, v[16:19] offset:45056
    ds_write_b128 v1, v[16:19] offset:49152
    ds_write_b128 v1, v[16:19] offset:53248
    v_lshlrev_b32 v9, 8, v8
    v_add_u32 v9, 158720, v9
    v_lshlrev_b32 v5, 4, v8
    v_mov_b32 v11, v5
    v_mov_b32 v13, v5
    v_mov_b32 v112, 0x3f803f80
    v_mov_b32 v113, 0
    v_mov_b32 v114, 0
    v_mov_b32 v115, 0
    s_mov_b32 s60, s28
    s_load_dwordx4 s[4:7], s[0:1], 16
    s_waitcnt lgkmcnt(0)
    s_mov_b32 s88, s4
    s_mov_b32 s89, s5
    s_mov_b32 s90, 3200000
    s_mov_b32 s91, 0x00020000
    s_mov_b32 s92, s6
    s_mov_b32 s93, s7
    s_mov_b32 s94, 3200000
    s_mov_b32 s95, 0x00020000
    s_barrier
k2_s_chunk:
    s_lshr_b32 s61, s29, 5
    s_lshl_b32 s61, s61, 8
    s_add_u32 s61, s61, s60
    s_lshl_b32 s61, s61, 4
    s_add_u32 s61, s61, 65536
    buffer_load_dwordx2 v[14:15], off, s[24:27], s61 sc1
    s_mov_b32 s63, 0
    s_waitcnt vmcnt(0)
    v_readfirstlane_b32 s84, v14
    v_readfirstlane_b32 s85, v15
    s_bitcmp1_b32 s85, s29
    s_cselect_b32 s56, 49, 12
    s_cselect_b32 s57, 36, 24
    s_bitcmp1_b32 s84, s29
    s_cselect_b32 s56, s57, s56
    s_bitcmp1_b32 s47, 1
    s_cselect_b32 s56, 49, s56
    s_mul_i32 s58, s60, 3125
    s_add_u32 s57, s58, 3125
    s_andn2_b32 s58, s58, 31
    s_andn2_b32 s57, s57, 31
    s_sub_u32 s57, s57, s58
    s_cmp_gt_u32 s56, 36
    s_cselect_b32 s57, s57, s56
k2_s_tile:
    s_cmp_ge_u32 s63, s57
    s_cbranch_scc1 k2_s_next
    v_add_u32 v1, s63, v7
    s_cmp_gt_u32 s56, 36
    s_cbranch_scc1 k2_s_scan
    s_and_b32 s84, s29, 1
    s_lshl_b32 s85, s84, 8
    s_add_u32 s85, s85, s60
    s_lshl_b32 s85, s85, 6
    s_lshl_b32 s59, s60, 1
    s_add_u32 s59, s59, s84
    s_lshl_b32 s59, s59, 6
    v_mul_u32_u24 v2, 86, v1
    v_lshrrev_b32 v2, 8, v2
    v_mul_u32_u24 v6, 3, v2
    v_sub_u32 v6, v1, v6
    v_lshrrev_b32 v4, 2, v2
    v_and_b32 v2, 3, v2
    v_lshlrev_b32 v2, 4, v2
    v_cmp_gt_u32 vcc, 12, v1
    v_lshl_add_u32 v4, v4, 15, s59
    v_mov_b32 v10, s85
    v_cndmask_b32 v4, v4, v10, vcc
    v_add_u32 v2, v2, v4
    buffer_load_dwordx4 v[116:119], v2, s[20:23], 0 offen sc1
    v_cmp_eq_u32 vcc, 1, v6
    v_cmp_eq_u32 s[84:85], 2, v6
    v_cmp_gt_u32 s[40:41], s56, v1
    v_mul_u32_u24 v6, 10, v6
    s_waitcnt vmcnt(0)
    v_cndmask_b32 v14, v116, v118, vcc
    v_cndmask_b32 v14, v14, v119, s[84:85]
    v_bfe_u32 v10, v117, v6, 10
    v_and_b32 v4, 0xffff, v14
    v_lshrrev_b32 v12, 16, v14
    v_add_u32 v12, s58, v12
    v_cmp_ne_u32 vcc, 0x3ff, v10
    v_lshrrev_b32 v10, 2, v10
    v_add_u32 v10, s30, v10
    s_and_b64 s[40:41], s[40:41], vcc
    s_cbranch_scc0 k2_s_skip
    s_branch k2_s_go
k2_s_scan:
    v_add_u32 v12, s58, v1
    v_lshlrev_b32 v2, 2, v12
    buffer_load_dword v4, v2, s[88:91], 0 offen
    buffer_load_dword v10, v2, s[92:95], 0 offen
    s_waitcnt vmcnt(0)
    v_subrev_u32 v2, s30, v10
    v_cmp_gt_u32 vcc, s31, v2
    v_cmp_gt_u32 s[40:41], s57, v1
    s_and_b64 s[40:41], s[40:41], vcc
    s_cbranch_scc0 k2_s_skip
k2_s_go:
    ds_read_b128 v[144:147], v9 offset:0
    ds_read_b128 v[148:151], v9 offset:16
    ds_read_b128 v[152:155], v9 offset:32
    ds_read_b128 v[156:159], v9 offset:48
    ds_read_b128 v[160:163], v9 offset:64
    ds_read_b128 v[164:167], v9 offset:80
    ds_read_b128 v[168:171], v9 offset:96
    ds_read_b128 v[172:175], v9 offset:112
    ds_read_b128 v[176:179], v9 offset:128
    ds_read_b128 v[180:183], v9 offset:144
    ds_read_b128 v[184:187], v9 offset:160
    ds_read_b128 v[188:191], v9 offset:176
    ds_read_b128 v[192:195], v9 offset:192
    ds_read_b128 v[196:199], v9 offset:208
    ds_read_b128 v[200:203], v9 offset:224
    ds_read_b128 v[204:207], v9 offset:240
    buffer_load_dwordx4 v[16:19], v[4:5], s[8:11], s33 idxen offen offset:0
    buffer_load_dwordx4 v[32:35], v[10:11], s[8:11], s33 idxen offen offset:0
    buffer_load_dwordx4 v[20:23], v[4:5], s[8:11], s33 idxen offen offset:32
    buffer_load_dwordx4 v[36:39], v[10:11], s[8:11], s33 idxen offen offset:32
    buffer_load_dwordx4 v[24:27], v[4:5], s[8:11], s33 idxen offen offset:64
    buffer_load_dwordx4 v[40:43], v[10:11], s[8:11], s33 idxen offen offset:64
    buffer_load_dwordx4 v[28:31], v[4:5], s[8:11], s33 idxen offen offset:96
    buffer_load_dwordx4 v[44:47], v[10:11], s[8:11], s33 idxen offen offset:96
    buffer_load_dwordx4 v[48:51], v[12:13], s[12:15], 0 idxen offen
    v_subrev_u32 v2, s30, v10
    v_mul_u32_u24 v2, 272, v2
    v_lshl_add_u32 v2, v8, 7, v2
    s_waitcnt vmcnt(0) lgkmcnt(0)
    v_mfma_f32_32x32x16_bf16 v[144:159], a[0:3], v[16:19], v[144:159]
    v_mfma_f32_32x32x16_bf16 v[144:159], a[4:7], v[20:23], v[144:159]
    v_mfma_f32_32x32x16_bf16 v[144:159], a[8:11], v[24:27], v[144:159]
    v_mfma_f32_32x32x16_bf16 v[144:159], a[12:15], v[28:31], v[144:159]
    v_mfma_f32_32x32x16_bf16 v[144:159], a[16:19], v[48:51], v[144:159]
    v_mfma_f32_32x32x16_bf16 v[144:159], a[80:83], v[32:35], v[144:159]
    v_mfma_f32_32x32x16_bf16 v[144:159], a[84:87], v[36:39], v[144:159]
    v_mfma_f32_32x32x16_bf16 v[144:159], a[88:91], v[40:43], v[144:159]
    v_mfma_f32_32x32x16_bf16 v[144:159], a[92:95], v[44:47], v[144:159]
    v_mfma_f32_32x32x16_bf16 v[160:175], a[20:23], v[16:19], v[160:175]
    v_mfma_f32_32x32x16_bf16 v[160:175], a[24:27], v[20:23], v[160:175]
    v_mfma_f32_32x32x16_bf16 v[160:175], a[28:31], v[24:27], v[160:175]
    v_mfma_f32_32x32x16_bf16 v[160:175], a[32:35], v[28:31], v[160:175]
    v_mfma_f32_32x32x16_bf16 v[160:175], a[36:39], v[48:51], v[160:175]
    v_mfma_f32_32x32x16_bf16 v[160:175], a[96:99], v[32:35], v[160:175]
    v_mfma_f32_32x32x16_bf16 v[160:175], a[100:103], v[36:39], v[160:175]
    v_mfma_f32_32x32x16_bf16 v[160:175], a[104:107], v[40:43], v[160:175]
    v_mfma_f32_32x32x16_bf16 v[160:175], a[108:111], v[44:47], v[160:175]
    v_mfma_f32_32x32x16_bf16 v[176:191], a[40:43], v[16:19], v[176:191]
    v_mfma_f32_32x32x16_bf16 v[176:191], a[44:47], v[20:23], v[176:191]
    v_mfma_f32_32x32x16_bf16 v[176:191], a[48:51], v[24:27], v[176:191]
    v_mfma_f32_32x32x16_bf16 v[176:191], a[52:55], v[28:31], v[176:191]
    v_mfma_f32_32x32x16_bf16 v[176:191], a[56:59], v[48:51], v[176:191]
    v_mfma_f32_32x32x16_bf16 v[176:191], a[112:115], v[32:35], v[176:191]
    v_mfma_f32_32x32x16_bf16 v[176:191], a[116:119], v[36:39], v[176:191]
    v_mfma_f32_32x32x16_bf16 v[176:191], a[120:123], v[40:43], v[176:191]
    v_mfma_f32_32x32x16_bf16 v[176:191], a[124:127], v[44:47], v[176:191]
    v_mfma_f32_32x32x16_bf16 v[192:207], a[60:63], v[16:19], v[192:207]
    v_mfma_f32_32x32x16_bf16 v[192:207], a[64:67], v[20:23], v[192:207]
    v_mfma_f32_32x32x16_bf16 v[192:207], a[68:71], v[24:27], v[192:207]
    v_mfma_f32_32x32x16_bf16 v[192:207], a[72:75], v[28:31], v[192:207]
    v_mfma_f32_32x32x16_bf16 v[192:207], a[76:79], v[48:51], v[192:207]
    v_mfma_f32_32x32x16_bf16 v[192:207], a[128:131], v[32:35], v[192:207]
    v_mfma_f32_32x32x16_bf16 v[192:207], a[132:135], v[36:39], v[192:207]
    v_mfma_f32_32x32x16_bf16 v[192:207], a[136:139], v[40:43], v[192:207]
    v_mfma_f32_32x32x16_bf16 v[192:207], a[140:143], v[44:47], v[192:207]
    v_mfma_f32_32x32x16_bf16 v[208:223], a[208:211], v[112:115], 0
    v_mfma_f32_32x32x16_bf16 v[224:239], a[212:215], v[112:115], 0
    s_nop 15
    v_exp_f32 v64, v144
    v_exp_f32 v65, v145
    v_exp_f32 v66, v146
    v_exp_f32 v67, v147
    v_exp_f32 v68, v148
    v_exp_f32 v69, v149
    v_exp_f32 v70, v150
    v_exp_f32 v71, v151
    v_exp_f32 v72, v152
    v_exp_f32 v73, v153
    v_exp_f32 v74, v154
    v_exp_f32 v75, v155
    v_exp_f32 v76, v156
    v_exp_f32 v77, v157
    v_exp_f32 v78, v158
    v_exp_f32 v79, v159
    v_add_f32 v64, 1.0, v64
    v_add_f32 v65, 1.0, v65
    v_add_f32 v66, 1.0, v66
    v_add_f32 v67, 1.0, v67
    v_add_f32 v68, 1.0, v68
    v_add_f32 v69, 1.0, v69
    v_add_f32 v70, 1.0, v70
    v_add_f32 v71, 1.0, v71
    v_add_f32 v72, 1.0, v72
    v_add_f32 v73, 1.0, v73
    v_add_f32 v74, 1.0, v74
    v_add_f32 v75, 1.0, v75
    v_add_f32 v76, 1.0, v76
    v_add_f32 v77, 1.0, v77
    v_add_f32 v78, 1.0, v78
    v_add_f32 v79, 1.0, v79
    v_rcp_f32 v64, v64
    v_rcp_f32 v65, v65
    v_rcp_f32 v66, v66
    v_rcp_f32 v67, v67
    v_rcp_f32 v68, v68
    v_rcp_f32 v69, v69
    v_rcp_f32 v70, v70
    v_rcp_f32 v71, v71
    v_rcp_f32 v72, v72
    v_rcp_f32 v73, v73
    v_rcp_f32 v74, v74
    v_rcp_f32 v75, v75
    v_rcp_f32 v76, v76
    v_rcp_f32 v77, v77
    v_rcp_f32 v78, v78
    v_rcp_f32 v79, v79
    v_mul_f32 v64, v144, v64
    v_mul_f32 v65, v145, v65
    v_mul_f32 v66, v146, v66
    v_mul_f32 v67, v147, v67
    v_mul_f32 v68, v148, v68
    v_mul_f32 v69, v149, v69
    v_mul_f32 v70, v150, v70
    v_mul_f32 v71, v151, v71
    v_mul_f32 v72, v152, v72
    v_mul_f32 v73, v153, v73
    v_mul_f32 v74, v154, v74
    v_mul_f32 v75, v155, v75
    v_mul_f32 v76, v156, v76
    v_mul_f32 v77, v157, v77
    v_mul_f32 v78, v158, v78
    v_mul_f32 v79, v159, v79
    v_cvt_pk_bf16_f32 v80, v64, v65
    v_cvt_pk_bf16_f32 v81, v66, v67
    v_cvt_pk_bf16_f32 v82, v68, v69
    v_cvt_pk_bf16_f32 v83, v70, v71
    v_cvt_pk_bf16_f32 v84, v72, v73
    v_cvt_pk_bf16_f32 v85, v74, v75
    v_cvt_pk_bf16_f32 v86, v76, v77
    v_cvt_pk_bf16_f32 v87, v78, v79
    v_exp_f32 v64, v160
    v_exp_f32 v65, v161
    v_exp_f32 v66, v162
    v_exp_f32 v67, v163
    v_exp_f32 v68, v164
    v_exp_f32 v69, v165
    v_exp_f32 v70, v166
    v_exp_f32 v71, v167
    v_exp_f32 v72, v168
    v_exp_f32 v73, v169
    v_exp_f32 v74, v170
    v_exp_f32 v75, v171
    v_exp_f32 v76, v172
    v_exp_f32 v77, v173
    v_exp_f32 v78, v174
    v_exp_f32 v79, v175
    v_add_f32 v64, 1.0, v64
    v_add_f32 v65, 1.0, v65
    v_add_f32 v66, 1.0, v66
    v_add_f32 v67, 1.0, v67
    v_add_f32 v68, 1.0, v68
    v_add_f32 v69, 1.0, v69
    v_add_f32 v70, 1.0, v70
    v_add_f32 v71, 1.0, v71
    v_add_f32 v72, 1.0, v72
    v_add_f32 v73, 1.0, v73
    v_add_f32 v74, 1.0, v74
    v_add_f32 v75, 1.0, v75
    v_add_f32 v76, 1.0, v76
    v_add_f32 v77, 1.0, v77
    v_add_f32 v78, 1.0, v78
    v_add_f32 v79, 1.0, v79
    v_rcp_f32 v64, v64
    v_rcp_f32 v65, v65
    v_rcp_f32 v66, v66
    v_rcp_f32 v67, v67
    v_rcp_f32 v68, v68
    v_rcp_f32 v69, v69
    v_rcp_f32 v70, v70
    v_rcp_f32 v71, v71
    v_rcp_f32 v72, v72
    v_rcp_f32 v73, v73
    v_rcp_f32 v74, v74
    v_rcp_f32 v75, v75
    v_rcp_f32 v76, v76
    v_rcp_f32 v77, v77
    v_rcp_f32 v78, v78
    v_rcp_f32 v79, v79
    v_mul_f32 v64, v160, v64
    v_mul_f32 v65, v161, v65
    v_mul_f32 v66, v162, v66
    v_mul_f32 v67, v163, v67
    v_mul_f32 v68, v164, v68
    v_mul_f32 v69, v165, v69
    v_mul_f32 v70, v166, v70
    v_mul_f32 v71, v167, v71
    v_mul_f32 v72, v168, v72
    v_mul_f32 v73, v169, v73
    v_mul_f32 v74, v170, v74
    v_mul_f32 v75, v171, v75
    v_mul_f32 v76, v172, v76
    v_mul_f32 v77, v173, v77
    v_mul_f32 v78, v174, v78
    v_mul_f32 v79, v175, v79
    v_cvt_pk_bf16_f32 v88, v64, v65
    v_cvt_pk_bf16_f32 v89, v66, v67
    v_cvt_pk_bf16_f32 v90, v68, v69
    v_cvt_pk_bf16_f32 v91, v70, v71
    v_cvt_pk_bf16_f32 v92, v72, v73
    v_cvt_pk_bf16_f32 v93, v74, v75
    v_cvt_pk_bf16_f32 v94, v76, v77
    v_cvt_pk_bf16_f32 v95, v78, v79
    v_exp_f32 v64, v176
    v_exp_f32 v65, v177
    v_exp_f32 v66, v178
    v_exp_f32 v67, v179
    v_exp_f32 v68, v180
    v_exp_f32 v69, v181
    v_exp_f32 v70, v182
    v_exp_f32 v71, v183
    v_exp_f32 v72, v184
    v_exp_f32 v73, v185
    v_exp_f32 v74, v186
    v_exp_f32 v75, v187
    v_exp_f32 v76, v188
    v_exp_f32 v77, v189
    v_exp_f32 v78, v190
    v_exp_f32 v79, v191
    v_add_f32 v64, 1.0, v64
    v_add_f32 v65, 1.0, v65
    v_add_f32 v66, 1.0, v66
    v_add_f32 v67, 1.0, v67
    v_add_f32 v68, 1.0, v68
    v_add_f32 v69, 1.0, v69
    v_add_f32 v70, 1.0, v70
    v_add_f32 v71, 1.0, v71
    v_add_f32 v72, 1.0, v72
    v_add_f32 v73, 1.0, v73
    v_add_f32 v74, 1.0, v74
    v_add_f32 v75, 1.0, v75
    v_add_f32 v76, 1.0, v76
    v_add_f32 v77, 1.0, v77
    v_add_f32 v78, 1.0, v78
    v_add_f32 v79, 1.0, v79
    v_rcp_f32 v64, v64
    v_rcp_f32 v65, v65
    v_rcp_f32 v66, v66
    v_rcp_f32 v67, v67
    v_rcp_f32 v68, v68
    v_rcp_f32 v69, v69
    v_rcp_f32 v70, v70
    v_rcp_f32 v71, v71
    v_rcp_f32 v72, v72
    v_rcp_f32 v73, v73
    v_rcp_f32 v74, v74
    v_rcp_f32 v75, v75
    v_rcp_f32 v76, v76
    v_rcp_f32 v77, v77
    v_rcp_f32 v78, v78
    v_rcp_f32 v79, v79
    v_mul_f32 v64, v176, v64
    v_mul_f32 v65, v177, v65
    v_mul_f32 v66, v178, v66
    v_mul_f32 v67, v179, v67
    v_mul_f32 v68, v180, v68
    v_mul_f32 v69, v181, v69
    v_mul_f32 v70, v182, v70
    v_mul_f32 v71, v183, v71
    v_mul_f32 v72, v184, v72
    v_mul_f32 v73, v185, v73
    v_mul_f32 v74, v186, v74
    v_mul_f32 v75, v187, v75
    v_mul_f32 v76, v188, v76
    v_mul_f32 v77, v189, v77
    v_mul_f32 v78, v190, v78
    v_mul_f32 v79, v191, v79
    v_cvt_pk_bf16_f32 v96, v64, v65
    v_cvt_pk_bf16_f32 v97, v66, v67
    v_cvt_pk_bf16_f32 v98, v68, v69
    v_cvt_pk_bf16_f32 v99, v70, v71
    v_cvt_pk_bf16_f32 v100, v72, v73
    v_cvt_pk_bf16_f32 v101, v74, v75
    v_cvt_pk_bf16_f32 v102, v76, v77
    v_cvt_pk_bf16_f32 v103, v78, v79
    v_exp_f32 v64, v192
    v_exp_f32 v65, v193
    v_exp_f32 v66, v194
    v_exp_f32 v67, v195
    v_exp_f32 v68, v196
    v_exp_f32 v69, v197
    v_exp_f32 v70, v198
    v_exp_f32 v71, v199
    v_exp_f32 v72, v200
    v_exp_f32 v73, v201
    v_exp_f32 v74, v202
    v_exp_f32 v75, v203
    v_exp_f32 v76, v204
    v_exp_f32 v77, v205
    v_exp_f32 v78, v206
    v_exp_f32 v79, v207
    v_add_f32 v64, 1.0, v64
    v_add_f32 v65, 1.0, v65
    v_add_f32 v66, 1.0, v66
    v_add_f32 v67, 1.0, v67
    v_add_f32 v68, 1.0, v68
    v_add_f32 v69, 1.0, v69
    v_add_f32 v70, 1.0, v70
    v_add_f32 v71, 1.0, v71
    v_add_f32 v72, 1.0, v72
    v_add_f32 v73, 1.0, v73
    v_add_f32 v74, 1.0, v74
    v_add_f32 v75, 1.0, v75
    v_add_f32 v76, 1.0, v76
    v_add_f32 v77, 1.0, v77
    v_add_f32 v78, 1.0, v78
    v_add_f32 v79, 1.0, v79
    v_rcp_f32 v64, v64
    v_rcp_f32 v65, v65
    v_rcp_f32 v66, v66
    v_rcp_f32 v67, v67
    v_rcp_f32 v68, v68
    v_rcp_f32 v69, v69
    v_rcp_f32 v70, v70
    v_rcp_f32 v71, v71
    v_rcp_f32 v72, v72
    v_rcp_f32 v73, v73
    v_rcp_f32 v74, v74
    v_rcp_f32 v75, v75
    v_rcp_f32 v76, v76
    v_rcp_f32 v77, v77
    v_rcp_f32 v78, v78
    v_rcp_f32 v79, v79
    v_mul_f32 v64, v192, v64
    v_mul_f32 v65, v193, v65
    v_mul_f32 v66, v194, v66
    v_mul_f32 v67, v195, v67
    v_mul_f32 v68, v196, v68
    v_mul_f32 v69, v197, v69
    v_mul_f32 v70, v198, v70
    v_mul_f32 v71, v199, v71
    v_mul_f32 v72, v200, v72
    v_mul_f32 v73, v201, v73
    v_mul_f32 v74, v202, v74
    v_mul_f32 v75, v203, v75
    v_mul_f32 v76, v204, v76
    v_mul_f32 v77, v205, v77
    v_mul_f32 v78, v206, v78
    v_mul_f32 v79, v207, v79
    v_cvt_pk_bf16_f32 v104, v64, v65
    v_cvt_pk_bf16_f32 v105, v66, v67
    v_cvt_pk_bf16_f32 v106, v68, v69
    v_cvt_pk_bf16_f32 v107, v70, v71
    v_cvt_pk_bf16_f32 v108, v72, v73
    v_cvt_pk_bf16_f32 v109, v74, v75
    v_cvt_pk_bf16_f32 v110, v76, v77
    v_cvt_pk_bf16_f32 v111, v78, v79
    s_nop 1
    v_mfma_f32_32x32x16_bf16 v[208:223], a[144:147], v[80:83], v[208:223]
    v_mfma_f32_32x32x16_bf16 v[224:239], a[148:151], v[80:83], v[224:239]
    v_mfma_f32_32x32x16_bf16 v[208:223], a[152:155], v[84:87], v[208:223]
    v_mfma_f32_32x32x16_bf16 v[224:239], a[156:159], v[84:87], v[224:239]
    v_mfma_f32_32x32x16_bf16 v[208:223], a[160:163], v[88:91], v[208:223]
    v_mfma_f32_32x32x16_bf16 v[224:239], a[164:167], v[88:91], v[224:239]
    v_mfma_f32_32x32x16_bf16 v[208:223], a[168:171], v[92:95], v[208:223]
    v_mfma_f32_32x32x16_bf16 v[224:239], a[172:175], v[92:95], v[224:239]
    v_mfma_f32_32x32x16_bf16 v[208:223], a[176:179], v[96:99], v[208:223]
    v_mfma_f32_32x32x16_bf16 v[224:239], a[180:183], v[96:99], v[224:239]
    v_mfma_f32_32x32x16_bf16 v[208:223], a[184:187], v[100:103], v[208:223]
    v_mfma_f32_32x32x16_bf16 v[224:239], a[188:191], v[100:103], v[224:239]
    v_mfma_f32_32x32x16_bf16 v[208:223], a[192:195], v[104:107], v[208:223]
    v_mfma_f32_32x32x16_bf16 v[224:239], a[196:199], v[104:107], v[224:239]
    v_mfma_f32_32x32x16_bf16 v[208:223], a[200:203], v[108:111], v[208:223]
    v_mfma_f32_32x32x16_bf16 v[224:239], a[204:207], v[108:111], v[224:239]
    s_nop 15
    v_mul_f32 v208, s44, v208
    v_mul_f32 v209, s44, v209
    v_mul_f32 v210, s44, v210
    v_mul_f32 v211, s44, v211
    v_mul_f32 v212, s44, v212
    v_mul_f32 v213, s44, v213
    v_mul_f32 v214, s44, v214
    v_mul_f32 v215, s44, v215
    v_mul_f32 v216, s44, v216
    v_mul_f32 v217, s44, v217
    v_mul_f32 v218, s44, v218
    v_mul_f32 v219, s44, v219
    v_mul_f32 v220, s44, v220
    v_mul_f32 v221, s44, v221
    v_mul_f32 v222, s44, v222
    v_mul_f32 v223, s44, v223
    v_mul_f32 v224, s44, v224
    v_mul_f32 v225, s44, v225
    v_mul_f32 v226, s44, v226
    v_mul_f32 v227, s44, v227
    v_mul_f32 v228, s44, v228
    v_mul_f32 v229, s44, v229
    v_mul_f32 v230, s44, v230
    v_mul_f32 v231, s44, v231
    v_mul_f32 v232, s44, v232
    v_mul_f32 v233, s44, v233
    v_mul_f32 v234, s44, v234
    v_mul_f32 v235, s44, v235
    v_mul_f32 v236, s44, v236
    v_mul_f32 v237, s44, v237
    v_mul_f32 v238, s44, v238
    v_mul_f32 v239, s44, v239
    s_mov_b64 exec, s[40:41]
    ds_add_f32 v2, v208 offset:0
    ds_add_f32 v2, v209 offset:4
    ds_add_f32 v2, v210 offset:8
    ds_add_f32 v2, v211 offset:12
    ds_add_f32 v2, v212 offset:16
    ds_add_f32 v2, v213 offset:20
    ds_add_f32 v2, v214 offset:24
    ds_add_f32 v2, v215 offset:28
    ds_add_f32 v2, v216 offset:32
    ds_add_f32 v2, v217 offset:36
    ds_add_f32 v2, v218 offset:40
    ds_add_f32 v2, v219 offset:44
    ds_add_f32 v2, v220 offset:48
    ds_add_f32 v2, v221 offset:52
    ds_add_f32 v2, v222 offset:56
    ds_add_f32 v2, v223 offset:60
    ds_add_f32 v2, v224 offset:64
    ds_add_f32 v2, v225 offset:68
    ds_add_f32 v2, v226 offset:72
    ds_add_f32 v2, v227 offset:76
    ds_add_f32 v2, v228 offset:80
    ds_add_f32 v2, v229 offset:84
    ds_add_f32 v2, v230 offset:88
    ds_add_f32 v2, v231 offset:92
    ds_add_f32 v2, v232 offset:96
    ds_add_f32 v2, v233 offset:100
    ds_add_f32 v2, v234 offset:104
    ds_add_f32 v2, v235 offset:108
    ds_add_f32 v2, v236 offset:112
    ds_add_f32 v2, v237 offset:116
    ds_add_f32 v2, v238 offset:120
    ds_add_f32 v2, v239 offset:124
    s_mov_b64 exec, -1
    s_waitcnt lgkmcnt(0)
k2_s_skip:
    s_add_u32 s63, s63, 32
    s_branch k2_s_tile
k2_s_next:
    s_add_u32 s60, s60, 4
    s_cmp_lt_u32 s60, 256
    s_cbranch_scc1 k2_s_chunk
    s_barrier
    v_lshrrev_b32 v1, 3, v0
    v_and_b32 v2, 7, v0
    v_mul_u32_u24 v4, 272, v1
    v_lshl_add_u32 v4, v2, 5, v4
    v_add_u32 v6, s30, v1
    v_lshlrev_b32 v6, 7, v6
    v_lshl_add_u32 v6, v2, 4, v6
    ds_read_b128 v[16:19], v4 offset:0
    ds_read_b128 v[20:23], v4 offset:16
    v_cmp_gt_u32 vcc, s31, v1
    s_nop 1
    v_cndmask_b32 v28, -1, v6, vcc
    v_add_u32 v1, 32, v1
    v_add_u32 v6, 4096, v6
    s_waitcnt lgkmcnt(0)
    v_cvt_pk_bf16_f32 v24, v16, v17
    v_cvt_pk_bf16_f32 v25, v18, v19
    v_cvt_pk_bf16_f32 v26, v20, v21
    v_cvt_pk_bf16_f32 v27, v22, v23
    buffer_store_dwordx4 v[24:27], v28, s[16:19], 0 offen
    s_waitcnt vmcnt(0)
    ds_read_b128 v[16:19], v4 offset:8704
    ds_read_b128 v[20:23], v4 offset:8720
    v_cmp_gt_u32 vcc, s31, v1
    s_nop 1
    v_cndmask_b32 v28, -1, v6, vcc
    v_add_u32 v1, 32, v1
    v_add_u32 v6, 4096, v6
    s_waitcnt lgkmcnt(0)
    v_cvt_pk_bf16_f32 v24, v16, v17
    v_cvt_pk_bf16_f32 v25, v18, v19
    v_cvt_pk_bf16_f32 v26, v20, v21
    v_cvt_pk_bf16_f32 v27, v22, v23
    buffer_store_dwordx4 v[24:27], v28, s[16:19], 0 offen
    s_waitcnt vmcnt(0)
    ds_read_b128 v[16:19], v4 offset:17408
    ds_read_b128 v[20:23], v4 offset:17424
    v_cmp_gt_u32 vcc, s31, v1
    s_nop 1
    v_cndmask_b32 v28, -1, v6, vcc
    v_add_u32 v1, 32, v1
    v_add_u32 v6, 4096, v6
    s_waitcnt lgkmcnt(0)
    v_cvt_pk_bf16_f32 v24, v16, v17
    v_cvt_pk_bf16_f32 v25, v18, v19
    v_cvt_pk_bf16_f32 v26, v20, v21
    v_cvt_pk_bf16_f32 v27, v22, v23
    buffer_store_dwordx4 v[24:27], v28, s[16:19], 0 offen
    s_waitcnt vmcnt(0)
    ds_read_b128 v[16:19], v4 offset:26112
    ds_read_b128 v[20:23], v4 offset:26128
    v_cmp_gt_u32 vcc, s31, v1
    s_nop 1
    v_cndmask_b32 v28, -1, v6, vcc
    v_add_u32 v1, 32, v1
    v_add_u32 v6, 4096, v6
    s_waitcnt lgkmcnt(0)
    v_cvt_pk_bf16_f32 v24, v16, v17
    v_cvt_pk_bf16_f32 v25, v18, v19
    v_cvt_pk_bf16_f32 v26, v20, v21
    v_cvt_pk_bf16_f32 v27, v22, v23
    buffer_store_dwordx4 v[24:27], v28, s[16:19], 0 offen
    s_waitcnt vmcnt(0)
    ds_read_b128 v[16:19], v4 offset:34816
    ds_read_b128 v[20:23], v4 offset:34832
    v_cmp_gt_u32 vcc, s31, v1
    s_nop 1
    v_cndmask_b32 v28, -1, v6, vcc
    v_add_u32 v1, 32, v1
    v_add_u32 v6, 4096, v6
    s_waitcnt lgkmcnt(0)
    v_cvt_pk_bf16_f32 v24, v16, v17
    v_cvt_pk_bf16_f32 v25, v18, v19
    v_cvt_pk_bf16_f32 v26, v20, v21
    v_cvt_pk_bf16_f32 v27, v22, v23
    buffer_store_dwordx4 v[24:27], v28, s[16:19], 0 offen
    s_waitcnt vmcnt(0)
    ds_read_b128 v[16:19], v4 offset:43520
    ds_read_b128 v[20:23], v4 offset:43536
    v_cmp_gt_u32 vcc, s31, v1
    s_nop 1
    v_cndmask_b32 v28, -1, v6, vcc
    v_add_u32 v1, 32, v1
    v_add_u32 v6, 4096, v6
    s_waitcnt lgkmcnt(0)
    v_cvt_pk_bf16_f32 v24, v16, v17
    v_cvt_pk_bf16_f32 v25, v18, v19
    v_cvt_pk_bf16_f32 v26, v20, v21
    v_cvt_pk_bf16_f32 v27, v22, v23
    buffer_store_dwordx4 v[24:27], v28, s[16:19], 0 offen
    s_waitcnt vmcnt(0)
    ds_read_b128 v[16:19], v4 offset:52224
    ds_read_b128 v[20:23], v4 offset:52240
    v_cmp_gt_u32 vcc, s31, v1
    s_nop 1
    v_cndmask_b32 v28, -1, v6, vcc
    v_add_u32 v1, 32, v1
    v_add_u32 v6, 4096, v6
    s_waitcnt lgkmcnt(0)
    v_cvt_pk_bf16_f32 v24, v16, v17
    v_cvt_pk_bf16_f32 v25, v18, v19
    v_cvt_pk_bf16_f32 v26, v20, v21
    v_cvt_pk_bf16_f32 v27, v22, v23
    buffer_store_dwordx4 v[24:27], v28, s[16:19], 0 offen
    s_waitcnt vmcnt(0)
    s_endpgm
.section .rodata,"a"
.p2align 6
.amdhsa_kernel standalone__edge_featured_mpnn_mpnn__graph_kernel
  .amdhsa_next_free_vgpr 512
  .amdhsa_next_free_sgpr 102
  .amdhsa_accum_offset 256
  .amdhsa_group_segment_fixed_size 0
  .amdhsa_kernarg_size 88
  .amdhsa_user_sgpr_count 2
  .amdhsa_user_sgpr_kernarg_segment_ptr 1
  .amdhsa_system_sgpr_workgroup_id_x 1
.end_amdhsa_kernel
```
